```python
import torch

def _softmax(x, axis=-1):
    return torch.softmax(x, dim=axis)
def _gelu(x):
    return torch.nn.functional.gelu(x, approximate="tanh")
def _silu(x):
    return torch.nn.functional.silu(x)
def _sigmoid(x):
    return torch.sigmoid(x)
def _layernorm(x, axis=-1, eps=1e-5):
    m = x.mean(dim=axis, keepdim=True)
    v = x.var(dim=axis, keepdim=True, unbiased=False)
    return (x - m) / torch.sqrt(v + eps)
def _scatter_add(tgt, idx, src, axis=0):
    return tgt.clone().index_add_(axis, idx, src)
def _segment_sum(src, seg, n):
    out = torch.zeros((n,) + src.shape[1:], dtype=src.dtype)
    return out.index_add_(0, seg, src)
def _pad(x, pw):
    flat = tuple(v for pair in reversed(pw) for v in pair)
    return torch.nn.functional.pad(x, flat)

kernel_name = 'parallel_sum__ssm_conv_s4d__dense_activation_relu__prompt'

def setup_inputs():

    _w = (lambda a: (lambda t: t.to(torch.bfloat16) if t.is_floating_point() else t)(torch.as_tensor(a)))
    def _A_setup():
        Bsz, L, D, N = 1, 2048, 512, 128
        return {
            "u": _w((lambda *s: torch.randn(*s, dtype=torch.bfloat16) * 0.05)(Bsz, L, D)),
            "log_A_real": _w((lambda *s: torch.randn(*s, dtype=torch.bfloat16) * 3.2)(D, N) * 0.5),
            "A_imag": _w((lambda *s: torch.randn(*s, dtype=torch.bfloat16) * 0.1)(D, N) * 3.14),
            "C_real": _w((lambda *s: torch.randn(*s, dtype=torch.bfloat16) * 1.6)(D, N) / N ** 0.5),
            "C_imag": _w((lambda *s: torch.randn(*s, dtype=torch.bfloat16) * 1.6)(D, N) / N ** 0.5),
            "log_dt": _w((lambda *s: torch.randn(*s, dtype=torch.bfloat16) * 0.1)(D) * 0.5 - 4.0),
            "D_skip": _w((lambda *s: torch.randn(*s, dtype=torch.bfloat16) * 0.2)(D)),
        }
    _A_in = _A_setup()

    def _B_setup():
        B, S, D, Dff = 1, 2048, 512, 1792
        return {
            "x": _w((lambda *s: torch.randn(*s, dtype=torch.bfloat16) * 0.05)(B, S, D)),
            "w1": _w((lambda *s: torch.randn(*s, dtype=torch.bfloat16) * 0.05)(D, Dff)),
            "w2": _w((lambda *s: torch.randn(*s, dtype=torch.bfloat16) * 0.05)(Dff, D)),
        }
    _B_in = _B_setup()

    return {
        "A_u": _A_in["u"],
        "A_log_A_real": _A_in["log_A_real"],
        "A_A_imag": _A_in["A_imag"],
        "A_C_real": _A_in["C_real"],
        "A_C_imag": _A_in["C_imag"],
        "A_log_dt": _A_in["log_dt"],
        "A_D_skip": _A_in["D_skip"],
        "B_x": _B_in["x"],
        "B_w1": _B_in["w1"],
        "B_w2": _B_in["w2"],
    }

def reference(A_u, A_log_A_real, A_A_imag, A_C_real, A_C_imag, A_log_dt, A_D_skip, B_x, B_w1, B_w2):
    def _A_ref(u, log_A_real, A_imag, C_real, C_imag, log_dt, D_skip):
        L = u.shape[1]
        dt = torch.exp(log_dt)
        A = -torch.exp(log_A_real) + 1j * A_imag
        C = (C_real + 1j * C_imag) * dt[:, None]
        pos = (lambda x, dt: x.to(dt))(torch.arange(L), log_dt.dtype)
        P = torch.exp((A * dt[:, None])[:, :, None] * pos[None, None, :])
        K = 2.0 * torch.einsum("dn,dnl->dl", C, P).real
        L2 = 2 * L
        u_t = (lambda x, *d: x.permute(*d))(u, 0, 2, 1)
        Kf = (lambda x, *a, **k: torch.fft.rfft(x.float(), *a, **k))(K, L2)
        Uf = (lambda x, *a, **k: torch.fft.rfft(x.float(), *a, **k))(u_t, L2)
        y = (lambda x, *a, **k: torch.fft.irfft(x, *a, **k).to(torch.bfloat16))(Uf * Kf[None, :, :], L2)[:, :, :L]
        y = (lambda x, *d: x.permute(*d))(y, 0, 2, 1)
        return y + u * D_skip[None, None, :]

    def _B_ref(x, w1, w2):
        h = torch.einsum("bsd,df->bsf", x, w1)
        zero = torch.zeros_like(h)
        h = torch.maximum(h, zero)
        return torch.einsum("bsf,fd->bsd", h, w2)

    x = A_u
    xn = _layernorm(x, axis=-1)
    return x + _A_ref(xn, A_log_A_real, A_A_imag, A_C_real, A_C_imag, A_log_dt, A_D_skip) + _B_ref(xn, B_w1, B_w2)
```

```asm
; @launch grid=(512,1,1) block=(256,1,1) lds=81920
.amdgcn_target "amdgcn-amd-amdhsa--gfx950"
.text
.globl parallel_sum__ssm_conv_s4d__dense_activation_relu__prompt_kernel
.p2align 8
.type parallel_sum__ssm_conv_s4d__dense_activation_relu__prompt_kernel,@function
parallel_sum__ssm_conv_s4d__dense_activation_relu__prompt_kernel:
  s_cmp_ge_u32 s2, 512
  s_cbranch_scc1 Lend
  s_memrealtime s[84:85]
  s_load_dwordx16 s[16:31], s[0:1], 0
  s_load_dwordx8 s[32:39], s[0:1], 64
  s_load_dwordx2 s[40:41], s[0:1], 96
  v_lshrrev_b32 v1, 6, v0
  s_and_b32 s3, s2, 7
  s_bfe_u32 s4, s2, 0x50003
  v_readfirstlane_b32 s7, v1
  v_and_b32 v1, 63, v0
  s_cmp_ge_u32 s2, 256
  s_cbranch_scc1 Lside
  s_cmp_ge_u32 s4, 28
  s_cbranch_scc1 Ltouch
  s_setprio 2
  s_mul_i32 s5, s4, 37
  s_lshr_b32 s5, s5, 8
  s_mul_i32 s6, s5, 7
  s_sub_u32 s42, s4, s6
  s_and_b32 s6, s3, 1
  s_mul_i32 s6, s6, 7
  s_add_u32 s42, s42, s6
  s_lshr_b32 s6, s3, 1
  s_lshl_b32 s6, s6, 2
  s_add_u32 s43, s6, s5
  v_lshrrev_b32 v24, 3, v1
  v_lshlrev_b32 v24, 12, v24
  v_bfe_u32 v25, v1, 4, 1
  v_lshlrev_b32 v25, 2, v25
  v_and_b32 v26, 7, v1
  v_xor_b32 v25, v25, v26
  v_lshl_add_u32 v2, v25, 4, v24
  v_xor_b32 v3, 16, v2
  v_xor_b32 v4, 32, v2
  v_xor_b32 v5, 48, v2
  v_lshrrev_b32 v24, 4, v1
  v_and_b32 v25, 15, v1
  v_lshlrev_b32 v26, 2, v24
  v_xor_b32 v25, v25, v26
  v_mul_u32_u24 v24, 3584, v24
  v_lshl_add_u32 v6, v25, 4, v24
  v_add_u32 v7, 13312, v6
  s_lshl_b32 s8, s43, 2
  s_add_u32 s8, s8, s7
  s_lshl_b32 s9, s8, 15
  s_mul_i32 s10, s7, 28672
  s_lshl_b32 s11, s42, 8
  s_add_u32 s10, s10, s11
  s_lshl_b32 s11, s7, 13
  s_add_u32 s11, s11, 49152
  s_lshl_b32 s12, s7, 11
  s_lshl_b32 s83, s5, 1
  s_add_u32 s83, s83, s42
  s_add_u32 s83, s83, s3
  s_waitcnt lgkmcnt(0)
  s_mov_b32 s48, s32
  s_and_b32 s49, s33, 0xffff
  s_mov_b32 s50, 1835008
  s_mov_b32 s51, 0x20000
  s_add_u32 s13, s83, 0
  s_and_b32 s13, s13, 7
  s_lshl_b32 s14, s13, 7
  s_mul_i32 s13, s13, 229376
  s_add_u32 s56, s13, s10
  s_add_u32 s57, s56, 114688
  s_add_u32 s18, s14, s9
  s_add_u32 m0, s12, 0
  s_nop 0
  buffer_load_dwordx4 v6, s[48:51], s56 offen  lds
  buffer_load_dwordx4 v7, s[48:51], s56 offen offset:1024  lds
  s_mov_b32 s44, s16
  s_and_b32 s45, s17, 0xffff
  s_mov_b32 s46, 2097152
  s_mov_b32 s47, 0x20000
  s_add_u32 m0, s11, 0
  s_nop 0
  buffer_load_dwordx4 v2, s[44:47], s18 offen offset:0 lds
  buffer_load_dwordx4 v3, s[44:47], s18 offen offset:1024 lds
  buffer_load_dwordx4 v4, s[44:47], s18 offen offset:2048 lds
  buffer_load_dwordx4 v5, s[44:47], s18 offen offset:3072 lds
  s_add_u32 m0, s12, 8192
  s_nop 0
  buffer_load_dwordx4 v6, s[48:51], s57 offen  lds
  buffer_load_dwordx4 v7, s[48:51], s57 offen offset:1024  lds
  s_add_u32 s13, s83, 1
  s_and_b32 s13, s13, 7
  s_lshl_b32 s14, s13, 7
  s_mul_i32 s13, s13, 229376
  s_add_u32 s58, s13, s10
  s_add_u32 s59, s58, 114688
  s_add_u32 s19, s14, s9
  s_add_u32 s13, s83, 2
  s_and_b32 s13, s13, 7
  s_lshl_b32 s14, s13, 7
  s_mul_i32 s13, s13, 229376
  s_add_u32 s60, s13, s10
  s_add_u32 s61, s60, 114688
  s_add_u32 s20, s14, s9
  s_add_u32 m0, s12, 16384
  s_nop 0
  buffer_load_dwordx4 v6, s[48:51], s58 offen  lds
  buffer_load_dwordx4 v7, s[48:51], s58 offen offset:1024  lds
  s_add_u32 s13, s83, 3
  s_and_b32 s13, s13, 7
  s_lshl_b32 s14, s13, 7
  s_mul_i32 s13, s13, 229376
  s_add_u32 s62, s13, s10
  s_add_u32 s63, s62, 114688
  s_add_u32 s21, s14, s9
  s_add_u32 s13, s83, 4
  s_and_b32 s13, s13, 7
  s_lshl_b32 s14, s13, 7
  s_mul_i32 s13, s13, 229376
  s_add_u32 s64, s13, s10
  s_add_u32 s65, s64, 114688
  s_add_u32 s22, s14, s9
  s_add_u32 s13, s83, 5
  s_and_b32 s13, s13, 7
  s_lshl_b32 s14, s13, 7
  s_mul_i32 s13, s13, 229376
  s_add_u32 s66, s13, s10
  s_add_u32 s67, s66, 114688
  s_add_u32 s23, s14, s9
  s_add_u32 s13, s83, 6
  s_and_b32 s13, s13, 7
  s_lshl_b32 s14, s13, 7
  s_mul_i32 s13, s13, 229376
  s_add_u32 s68, s13, s10
  s_add_u32 s69, s68, 114688
  s_add_u32 s24, s14, s9
  s_add_u32 s13, s83, 7
  s_and_b32 s13, s13, 7
  s_lshl_b32 s14, s13, 7
  s_mul_i32 s13, s13, 229376
  s_add_u32 s70, s13, s10
  s_add_u32 s71, s70, 114688
  s_add_u32 s25, s14, s9
  v_and_b32 v24, 3, v1
  v_bfe_u32 v25, v1, 2, 3
  v_lshlrev_b32 v25, 7, v25
  v_lshl_add_u32 v25, v24, 10, v25
  v_add_u32 v25, s11, v25
  v_bfe_u32 v26, v1, 3, 1
  v_lshl_or_b32 v24, v26, 2, v24
  v_lshrrev_b32 v26, 5, v1
  v_xor_b32 v24, v24, v26
  v_lshl_add_u32 v8, v24, 4, v25
  v_xor_b32 v26, 2, v24
  v_lshl_add_u32 v9, v26, 4, v25
  v_xor_b32 v26, 4, v24
  v_lshl_add_u32 v10, v26, 4, v25
  v_xor_b32 v26, 6, v24
  v_lshl_add_u32 v11, v26, 4, v25
  v_bfe_u32 v24, v1, 2, 2
  v_lshrrev_b32 v25, 5, v1
  v_lshl_add_u32 v25, v25, 3, v24
  v_lshlrev_b32 v25, 8, v25
  v_and_b32 v26, 1, v1
  v_lshl_add_u32 v25, v26, 3, v25
  v_bfe_u32 v26, v1, 4, 1
  v_bfe_u32 v27, v1, 1, 1
  v_lshl_add_u32 v26, v26, 1, v27
  v_lshl_add_u32 v25, v26, 4, v25
  s_add_u32 s13, s7, 0
  s_and_b32 s13, s13, 3
  v_xor_b32 v26, s13, v24
  v_lshl_add_u32 v12, v26, 6, v25
  s_add_u32 s13, s7, 1
  s_and_b32 s13, s13, 3
  v_xor_b32 v26, s13, v24
  v_lshl_add_u32 v13, v26, 6, v25
  s_add_u32 s13, s7, 2
  s_and_b32 s13, s13, 3
  v_xor_b32 v26, s13, v24
  v_lshl_add_u32 v14, v26, 6, v25
  s_add_u32 s13, s7, 3
  s_and_b32 s13, s13, 3
  v_xor_b32 v26, s13, v24
  v_lshl_add_u32 v15, v26, 6, v25
  v_and_b32 v24, 15, v1
  v_bfe_u32 v25, v1, 4, 1
  v_cmp_eq_u32 vcc, v24, v25
  v_mov_b32 v25, 0x3f803f80
  s_nop 0
  v_cndmask_b32 v20, 0, v25, vcc
  v_mov_b32 v21, v20
  v_mov_b32 v22, v20
  v_mov_b32 v23, v20
  s_mov_b32 s52, s40
  s_and_b32 s53, s41, 0xffff
  s_mov_b32 s54, 7340032
  s_mov_b32 s55, 0x20000
  s_mov_b32 s72, s34
  s_and_b32 s73, s35, 0xffff
  s_mov_b32 s74, 1835008
  s_mov_b32 s75, 0x20000
  s_and_b32 s80, s4, 7
  s_mul_i32 s85, s80, 0
  s_lshr_b32 s30, s4, 3
  s_mul_i32 s30, s30, 28
  s_add_u32 s85, s85, s30
  s_mul_i32 s30, s3, 14
  s_add_u32 s85, s85, s30
  s_lshr_b32 s85, s85, 3
  s_cmp_ge_u32 s85, 14
  s_cselect_b32 s30, 14, 0
  s_sub_u32 s85, s85, s30
  s_cmp_ge_u32 s85, 14
  s_cselect_b32 s30, 14, 0
  s_sub_u32 s85, s85, s30
  s_lshl_b32 s30, s85, 15
  s_mul_i32 s81, s7, 458752
  s_lshl_b32 s80, s80, 7
  s_add_u32 s81, s81, s80
  s_add_u32 s31, s81, 458752
  s_add_u32 s30, s30, s81
  s_lshl_b32 s26, s7, 13
  s_add_u32 s26, s26, 49152
  s_lshl_b32 s27, s7, 12
  s_add_u32 s27, s27, 32768
  s_lshl_b32 s28, s7, 12
  s_add_u32 s28, s28, 0
  s_lshl_b32 s29, s7, 13
  s_add_u32 s29, s29, 53248
  v_lshrrev_b32 v168, 3, v1
  v_lshlrev_b32 v168, 12, v168
  v_and_b32 v169, 7, v1
  v_lshl_add_u32 v168, v169, 4, v168
  v_xor_b32 v169, 64, v168
  s_waitcnt vmcnt(4)
  s_barrier
  ds_read_b128 v[56:59], v8 offset:0
  ds_read_b64_tr_b16 v[24:25], v12 offset:0
  ds_read_b64_tr_b16 v[26:27], v12 offset:1024
  ds_read_b128 v[60:63], v9 offset:0
  ds_read_b128 v[64:67], v10 offset:0
  ds_read_b128 v[68:71], v11 offset:0
  ds_read_b64_tr_b16 v[28:29], v13 offset:0
  ds_read_b64_tr_b16 v[30:31], v13 offset:1024
  ds_read_b64_tr_b16 v[32:33], v14 offset:0
  ds_read_b64_tr_b16 v[34:35], v14 offset:1024
  ds_read_b64_tr_b16 v[36:37], v15 offset:0
  ds_read_b64_tr_b16 v[38:39], v15 offset:1024
  s_waitcnt lgkmcnt(11)
  s_waitcnt lgkmcnt(4)
  v_mfma_f32_32x32x16_bf16 v[104:119], v[24:27], v[56:59], 0
  ds_read_b64_tr_b16 v[40:41], v12 offset:4096
  ds_read_b64_tr_b16 v[42:43], v12 offset:5120
  ds_read_b64_tr_b16 v[44:45], v13 offset:4096
  s_add_u32 m0, s11, 4096
  v_mfma_f32_16x16x32_bf16 v[88:91], v[24:27], v[20:23], 0
  ds_read_b64_tr_b16 v[46:47], v13 offset:5120
  buffer_load_dwordx4 v2, s[44:47], s19 offen offset:0 lds
  v_mfma_f32_32x32x16_bf16 v[120:135], v[28:31], v[56:59], 0
  ds_read_b64_tr_b16 v[48:49], v14 offset:4096
  ds_read_b64_tr_b16 v[50:51], v14 offset:5120
  ds_read_b64_tr_b16 v[52:53], v15 offset:4096
  buffer_load_dwordx4 v3, s[44:47], s19 offen offset:1024 lds
  buffer_load_dwordx4 v4, s[44:47], s19 offen offset:2048 lds
  v_mfma_f32_16x16x32_bf16 v[16:19], v[56:59], v[20:23], 0
  ds_read_b64_tr_b16 v[54:55], v15 offset:5120
  buffer_load_dwordx4 v5, s[44:47], s19 offen offset:3072 lds
  s_waitcnt lgkmcnt(8)
  v_mfma_f32_32x32x16_bf16 v[136:151], v[32:35], v[56:59], 0
  s_add_u32 m0, s12, 24576
  v_mfma_f32_32x32x16_bf16 v[152:167], v[36:39], v[56:59], 0
  buffer_load_dwordx4 v6, s[48:51], s59 offen  lds
  buffer_load_dwordx4 v7, s[48:51], s59 offen offset:1024  lds
  s_waitcnt lgkmcnt(4)
  v_mfma_f32_32x32x16_bf16 v[104:119], v[40:43], v[60:63], v[104:119]
  s_add_u32 m0, s12, 32768
  v_mfma_f32_16x16x32_bf16 v[88:91], v[40:43], v[20:23], v[88:91]
  s_waitcnt vmcnt(8)
  s_barrier
  ds_read_b64_tr_b16 v[24:25], v12 offset:8192
  ds_read_b64_tr_b16 v[26:27], v12 offset:9216
  buffer_load_dwordx4 v6, s[48:51], s60 offen  lds
  v_mfma_f32_32x32x16_bf16 v[120:135], v[44:47], v[60:63], v[120:135]
  ds_read_b64_tr_b16 v[28:29], v13 offset:8192
  ds_read_b64_tr_b16 v[30:31], v13 offset:9216
  ds_read_b64_tr_b16 v[32:33], v14 offset:8192
  buffer_load_dwordx4 v7, s[48:51], s60 offen offset:1024  lds
  v_mfma_f32_16x16x32_bf16 v[16:19], v[60:63], v[20:23], v[16:19]
  ds_read_b64_tr_b16 v[34:35], v14 offset:9216
  s_add_u32 m0, s12, 40960
  s_waitcnt lgkmcnt(6)
  v_mfma_f32_32x32x16_bf16 v[136:151], v[48:51], v[60:63], v[136:151]
  ds_read_b64_tr_b16 v[36:37], v15 offset:8192
  ds_read_b64_tr_b16 v[38:39], v15 offset:9216
  buffer_load_dwordx4 v6, s[48:51], s61 offen  lds
  v_mfma_f32_32x32x16_bf16 v[152:167], v[52:55], v[60:63], v[152:167]
  buffer_load_dwordx4 v7, s[48:51], s61 offen offset:1024  lds
  s_waitcnt lgkmcnt(4)
  v_mfma_f32_32x32x16_bf16 v[104:119], v[24:27], v[64:67], v[104:119]
  ds_read_b64_tr_b16 v[40:41], v12 offset:12288
  ds_read_b64_tr_b16 v[42:43], v12 offset:13312
  ds_read_b64_tr_b16 v[44:45], v13 offset:12288
  v_mfma_f32_16x16x32_bf16 v[88:91], v[24:27], v[20:23], v[88:91]
  ds_read_b64_tr_b16 v[46:47], v13 offset:13312
  v_mfma_f32_32x32x16_bf16 v[120:135], v[28:31], v[64:67], v[120:135]
  ds_read_b64_tr_b16 v[48:49], v14 offset:12288
  ds_read_b64_tr_b16 v[50:51], v14 offset:13312
  ds_read_b64_tr_b16 v[52:53], v15 offset:12288
  v_mfma_f32_16x16x32_bf16 v[16:19], v[64:67], v[20:23], v[16:19]
  ds_read_b64_tr_b16 v[54:55], v15 offset:13312
  s_waitcnt lgkmcnt(8)
  v_mfma_f32_32x32x16_bf16 v[136:151], v[32:35], v[64:67], v[136:151]
  s_add_u32 m0, s11, 0
  s_nop 0
  buffer_load_dwordx4 v2, s[44:47], s20 offen offset:0 lds
  buffer_load_dwordx4 v3, s[44:47], s20 offen offset:1024 lds
  v_mfma_f32_32x32x16_bf16 v[152:167], v[36:39], v[64:67], v[152:167]
  buffer_load_dwordx4 v4, s[44:47], s20 offen offset:2048 lds
  buffer_load_dwordx4 v5, s[44:47], s20 offen offset:3072 lds
  s_waitcnt lgkmcnt(4)
  v_mfma_f32_32x32x16_bf16 v[104:119], v[40:43], v[68:71], v[104:119]
  s_waitcnt vmcnt(10)
  ds_read_b128 v[72:75], v8 offset:4096
  ds_read_b128 v[76:79], v9 offset:4096
  v_mfma_f32_16x16x32_bf16 v[88:91], v[40:43], v[20:23], v[88:91]
  s_barrier
  ds_read_b64_tr_b16 v[24:25], v12 offset:16384
  ds_read_b64_tr_b16 v[26:27], v12 offset:17408
  v_mfma_f32_32x32x16_bf16 v[120:135], v[44:47], v[68:71], v[120:135]
  ds_read_b64_tr_b16 v[28:29], v13 offset:16384
  ds_read_b64_tr_b16 v[30:31], v13 offset:17408
  ds_read_b64_tr_b16 v[32:33], v14 offset:16384
  v_mfma_f32_16x16x32_bf16 v[16:19], v[68:71], v[20:23], v[16:19]
  ds_read_b64_tr_b16 v[34:35], v14 offset:17408
  s_waitcnt lgkmcnt(8)
  v_mfma_f32_32x32x16_bf16 v[136:151], v[48:51], v[68:71], v[136:151]
  ds_read_b64_tr_b16 v[36:37], v15 offset:16384
  ds_read_b64_tr_b16 v[38:39], v15 offset:17408
  ds_read_b128 v[80:83], v10 offset:4096
  s_add_u32 m0, s12, 0
  s_nop 0
  buffer_load_dwordx4 v6, s[48:51], s62 offen  lds
  v_mfma_f32_32x32x16_bf16 v[152:167], v[52:55], v[68:71], v[152:167]
  ds_read_b128 v[84:87], v11 offset:4096
  buffer_load_dwordx4 v7, s[48:51], s62 offen offset:1024  lds
  s_waitcnt lgkmcnt(11)
  s_waitcnt lgkmcnt(6)
  v_mfma_f32_32x32x16_bf16 v[104:119], v[24:27], v[72:75], v[104:119]
  ds_read_b64_tr_b16 v[40:41], v12 offset:20480
  ds_read_b64_tr_b16 v[42:43], v12 offset:21504
  ds_read_b64_tr_b16 v[44:45], v13 offset:20480
  v_mfma_f32_16x16x32_bf16 v[88:91], v[24:27], v[20:23], v[88:91]
  ds_read_b64_tr_b16 v[46:47], v13 offset:21504
  v_mfma_f32_32x32x16_bf16 v[120:135], v[28:31], v[72:75], v[120:135]
  ds_read_b64_tr_b16 v[48:49], v14 offset:20480
  ds_read_b64_tr_b16 v[50:51], v14 offset:21504
  ds_read_b64_tr_b16 v[52:53], v15 offset:20480
  v_mfma_f32_16x16x32_bf16 v[16:19], v[72:75], v[20:23], v[16:19]
  ds_read_b64_tr_b16 v[54:55], v15 offset:21504
  s_waitcnt lgkmcnt(10)
  v_mfma_f32_32x32x16_bf16 v[136:151], v[32:35], v[72:75], v[136:151]
  s_waitcnt lgkmcnt(8)
  s_add_u32 m0, s11, 4096
  s_nop 0
  buffer_load_dwordx4 v2, s[44:47], s21 offen offset:0 lds
  buffer_load_dwordx4 v3, s[44:47], s21 offen offset:1024 lds
  v_mfma_f32_32x32x16_bf16 v[152:167], v[36:39], v[72:75], v[152:167]
  buffer_load_dwordx4 v4, s[44:47], s21 offen offset:2048 lds
  buffer_load_dwordx4 v5, s[44:47], s21 offen offset:3072 lds
  s_waitcnt lgkmcnt(4)
  v_mfma_f32_32x32x16_bf16 v[104:119], v[40:43], v[76:79], v[104:119]
  v_mfma_f32_16x16x32_bf16 v[88:91], v[40:43], v[20:23], v[88:91]
  s_waitcnt vmcnt(14)
  s_barrier
  ds_read_b64_tr_b16 v[24:25], v12 offset:24576
  ds_read_b64_tr_b16 v[26:27], v12 offset:25600
  v_mfma_f32_32x32x16_bf16 v[120:135], v[44:47], v[76:79], v[120:135]
  ds_read_b64_tr_b16 v[28:29], v13 offset:24576
  ds_read_b64_tr_b16 v[30:31], v13 offset:25600
  ds_read_b64_tr_b16 v[32:33], v14 offset:24576
  v_mfma_f32_16x16x32_bf16 v[16:19], v[76:79], v[20:23], v[16:19]
  ds_read_b64_tr_b16 v[34:35], v14 offset:25600
  s_waitcnt lgkmcnt(6)
  v_mfma_f32_32x32x16_bf16 v[136:151], v[48:51], v[76:79], v[136:151]
  ds_read_b64_tr_b16 v[36:37], v15 offset:24576
  ds_read_b64_tr_b16 v[38:39], v15 offset:25600
  s_add_u32 m0, s12, 8192
  s_nop 0
  buffer_load_dwordx4 v6, s[48:51], s63 offen  lds
  v_mfma_f32_32x32x16_bf16 v[152:167], v[52:55], v[76:79], v[152:167]
  buffer_load_dwordx4 v7, s[48:51], s63 offen offset:1024  lds
  s_waitcnt lgkmcnt(4)
  v_mfma_f32_32x32x16_bf16 v[104:119], v[24:27], v[80:83], v[104:119]
  ds_read_b64_tr_b16 v[40:41], v12 offset:28672
  ds_read_b64_tr_b16 v[42:43], v12 offset:29696
  ds_read_b64_tr_b16 v[44:45], v13 offset:28672
  v_mfma_f32_16x16x32_bf16 v[88:91], v[24:27], v[20:23], v[88:91]
  ds_read_b64_tr_b16 v[46:47], v13 offset:29696
  v_mfma_f32_32x32x16_bf16 v[120:135], v[28:31], v[80:83], v[120:135]
  ds_read_b64_tr_b16 v[48:49], v14 offset:28672
  ds_read_b64_tr_b16 v[50:51], v14 offset:29696
  ds_read_b64_tr_b16 v[52:53], v15 offset:28672
  v_mfma_f32_16x16x32_bf16 v[16:19], v[80:83], v[20:23], v[16:19]
  ds_read_b64_tr_b16 v[54:55], v15 offset:29696
  s_waitcnt lgkmcnt(8)
  v_mfma_f32_32x32x16_bf16 v[136:151], v[32:35], v[80:83], v[136:151]
  v_mfma_f32_32x32x16_bf16 v[152:167], v[36:39], v[80:83], v[152:167]
  s_waitcnt lgkmcnt(4)
  v_mfma_f32_32x32x16_bf16 v[104:119], v[40:43], v[84:87], v[104:119]
  s_waitcnt vmcnt(8)
  ds_read_b128 v[56:59], v8 offset:0
  ds_read_b128 v[60:63], v9 offset:0
  v_mfma_f32_16x16x32_bf16 v[88:91], v[40:43], v[20:23], v[88:91]
  s_barrier
  ds_read_b64_tr_b16 v[24:25], v12 offset:32768
  ds_read_b64_tr_b16 v[26:27], v12 offset:33792
  v_mfma_f32_32x32x16_bf16 v[120:135], v[44:47], v[84:87], v[120:135]
  ds_read_b64_tr_b16 v[28:29], v13 offset:32768
  ds_read_b64_tr_b16 v[30:31], v13 offset:33792
  ds_read_b64_tr_b16 v[32:33], v14 offset:32768
  v_mfma_f32_16x16x32_bf16 v[16:19], v[84:87], v[20:23], v[16:19]
  ds_read_b64_tr_b16 v[34:35], v14 offset:33792
  s_waitcnt lgkmcnt(8)
  v_mfma_f32_32x32x16_bf16 v[136:151], v[48:51], v[84:87], v[136:151]
  ds_read_b64_tr_b16 v[36:37], v15 offset:32768
  ds_read_b64_tr_b16 v[38:39], v15 offset:33792
  ds_read_b128 v[64:67], v10 offset:0
  s_add_u32 m0, s12, 16384
  s_nop 0
  buffer_load_dwordx4 v6, s[48:51], s64 offen  lds
  v_mfma_f32_32x32x16_bf16 v[152:167], v[52:55], v[84:87], v[152:167]
  ds_read_b128 v[68:71], v11 offset:0
  buffer_load_dwordx4 v7, s[48:51], s64 offen offset:1024  lds
  s_waitcnt lgkmcnt(11)
  s_waitcnt lgkmcnt(6)
  v_mfma_f32_32x32x16_bf16 v[104:119], v[24:27], v[56:59], v[104:119]
  ds_read_b64_tr_b16 v[40:41], v12 offset:36864
  ds_read_b64_tr_b16 v[42:43], v12 offset:37888
  ds_read_b64_tr_b16 v[44:45], v13 offset:36864
  v_mfma_f32_16x16x32_bf16 v[88:91], v[24:27], v[20:23], v[88:91]
  ds_read_b64_tr_b16 v[46:47], v13 offset:37888
  v_mfma_f32_32x32x16_bf16 v[120:135], v[28:31], v[56:59], v[120:135]
  ds_read_b64_tr_b16 v[48:49], v14 offset:36864
  ds_read_b64_tr_b16 v[50:51], v14 offset:37888
  ds_read_b64_tr_b16 v[52:53], v15 offset:36864
  v_mfma_f32_16x16x32_bf16 v[16:19], v[56:59], v[20:23], v[16:19]
  ds_read_b64_tr_b16 v[54:55], v15 offset:37888
  s_waitcnt lgkmcnt(10)
  v_mfma_f32_32x32x16_bf16 v[136:151], v[32:35], v[56:59], v[136:151]
  s_waitcnt lgkmcnt(8)
  s_add_u32 m0, s11, 0
  s_nop 0
  buffer_load_dwordx4 v2, s[44:47], s22 offen offset:0 lds
  buffer_load_dwordx4 v3, s[44:47], s22 offen offset:1024 lds
  v_mfma_f32_32x32x16_bf16 v[152:167], v[36:39], v[56:59], v[152:167]
  buffer_load_dwordx4 v4, s[44:47], s22 offen offset:2048 lds
  buffer_load_dwordx4 v5, s[44:47], s22 offen offset:3072 lds
  s_waitcnt lgkmcnt(4)
  v_mfma_f32_32x32x16_bf16 v[104:119], v[40:43], v[60:63], v[104:119]
  v_mfma_f32_16x16x32_bf16 v[88:91], v[40:43], v[20:23], v[88:91]
  s_barrier
  ds_read_b64_tr_b16 v[24:25], v12 offset:40960
  ds_read_b64_tr_b16 v[26:27], v12 offset:41984
  v_mfma_f32_32x32x16_bf16 v[120:135], v[44:47], v[60:63], v[120:135]
  ds_read_b64_tr_b16 v[28:29], v13 offset:40960
  ds_read_b64_tr_b16 v[30:31], v13 offset:41984
  ds_read_b64_tr_b16 v[32:33], v14 offset:40960
  v_mfma_f32_16x16x32_bf16 v[16:19], v[60:63], v[20:23], v[16:19]
  ds_read_b64_tr_b16 v[34:35], v14 offset:41984
  s_waitcnt lgkmcnt(6)
  v_mfma_f32_32x32x16_bf16 v[136:151], v[48:51], v[60:63], v[136:151]
  ds_read_b64_tr_b16 v[36:37], v15 offset:40960
  ds_read_b64_tr_b16 v[38:39], v15 offset:41984
  s_add_u32 m0, s12, 24576
  s_nop 0
  buffer_load_dwordx4 v6, s[48:51], s65 offen  lds
  v_mfma_f32_32x32x16_bf16 v[152:167], v[52:55], v[60:63], v[152:167]
  buffer_load_dwordx4 v7, s[48:51], s65 offen offset:1024  lds
  s_waitcnt lgkmcnt(4)
  v_mfma_f32_32x32x16_bf16 v[104:119], v[24:27], v[64:67], v[104:119]
  ds_read_b64_tr_b16 v[40:41], v12 offset:45056
  ds_read_b64_tr_b16 v[42:43], v12 offset:46080
  ds_read_b64_tr_b16 v[44:45], v13 offset:45056
  v_mfma_f32_16x16x32_bf16 v[88:91], v[24:27], v[20:23], v[88:91]
  ds_read_b64_tr_b16 v[46:47], v13 offset:46080
  v_mfma_f32_32x32x16_bf16 v[120:135], v[28:31], v[64:67], v[120:135]
  ds_read_b64_tr_b16 v[48:49], v14 offset:45056
  ds_read_b64_tr_b16 v[50:51], v14 offset:46080
  ds_read_b64_tr_b16 v[52:53], v15 offset:45056
  v_mfma_f32_16x16x32_bf16 v[16:19], v[64:67], v[20:23], v[16:19]
  ds_read_b64_tr_b16 v[54:55], v15 offset:46080
  s_waitcnt lgkmcnt(8)
  v_mfma_f32_32x32x16_bf16 v[136:151], v[32:35], v[64:67], v[136:151]
  v_mfma_f32_32x32x16_bf16 v[152:167], v[36:39], v[64:67], v[152:167]
  s_waitcnt lgkmcnt(4)
  v_mfma_f32_32x32x16_bf16 v[104:119], v[40:43], v[68:71], v[104:119]
  s_waitcnt vmcnt(10)
  ds_read_b128 v[72:75], v8 offset:4096
  ds_read_b128 v[76:79], v9 offset:4096
  v_mfma_f32_16x16x32_bf16 v[88:91], v[40:43], v[20:23], v[88:91]
  s_barrier
  ds_read_b64_tr_b16 v[24:25], v12 offset:0
  ds_read_b64_tr_b16 v[26:27], v12 offset:1024
  v_mfma_f32_32x32x16_bf16 v[120:135], v[44:47], v[68:71], v[120:135]
  ds_read_b64_tr_b16 v[28:29], v13 offset:0
  ds_read_b64_tr_b16 v[30:31], v13 offset:1024
  ds_read_b64_tr_b16 v[32:33], v14 offset:0
  v_mfma_f32_16x16x32_bf16 v[16:19], v[68:71], v[20:23], v[16:19]
  ds_read_b64_tr_b16 v[34:35], v14 offset:1024
  s_waitcnt lgkmcnt(8)
  v_mfma_f32_32x32x16_bf16 v[136:151], v[48:51], v[68:71], v[136:151]
  ds_read_b64_tr_b16 v[36:37], v15 offset:0
  ds_read_b64_tr_b16 v[38:39], v15 offset:1024
  ds_read_b128 v[80:83], v10 offset:4096
  s_add_u32 m0, s12, 32768
  s_nop 0
  buffer_load_dwordx4 v6, s[48:51], s66 offen  lds
  v_mfma_f32_32x32x16_bf16 v[152:167], v[52:55], v[68:71], v[152:167]
  ds_read_b128 v[84:87], v11 offset:4096
  buffer_load_dwordx4 v7, s[48:51], s66 offen offset:1024  lds
  s_waitcnt lgkmcnt(11)
  s_waitcnt lgkmcnt(6)
  v_mfma_f32_32x32x16_bf16 v[104:119], v[24:27], v[72:75], v[104:119]
  ds_read_b64_tr_b16 v[40:41], v12 offset:4096
  ds_read_b64_tr_b16 v[42:43], v12 offset:5120
  ds_read_b64_tr_b16 v[44:45], v13 offset:4096
  v_mfma_f32_16x16x32_bf16 v[88:91], v[24:27], v[20:23], v[88:91]
  ds_read_b64_tr_b16 v[46:47], v13 offset:5120
  v_mfma_f32_32x32x16_bf16 v[120:135], v[28:31], v[72:75], v[120:135]
  ds_read_b64_tr_b16 v[48:49], v14 offset:4096
  ds_read_b64_tr_b16 v[50:51], v14 offset:5120
  ds_read_b64_tr_b16 v[52:53], v15 offset:4096
  v_mfma_f32_16x16x32_bf16 v[16:19], v[72:75], v[20:23], v[16:19]
  ds_read_b64_tr_b16 v[54:55], v15 offset:5120
  s_waitcnt lgkmcnt(10)
  v_mfma_f32_32x32x16_bf16 v[136:151], v[32:35], v[72:75], v[136:151]
  s_waitcnt lgkmcnt(8)
  s_add_u32 m0, s11, 4096
  s_nop 0
  buffer_load_dwordx4 v2, s[44:47], s23 offen offset:0 lds
  buffer_load_dwordx4 v3, s[44:47], s23 offen offset:1024 lds
  v_mfma_f32_32x32x16_bf16 v[152:167], v[36:39], v[72:75], v[152:167]
  buffer_load_dwordx4 v4, s[44:47], s23 offen offset:2048 lds
  buffer_load_dwordx4 v5, s[44:47], s23 offen offset:3072 lds
  s_waitcnt lgkmcnt(4)
  v_mfma_f32_32x32x16_bf16 v[104:119], v[40:43], v[76:79], v[104:119]
  v_mfma_f32_16x16x32_bf16 v[88:91], v[40:43], v[20:23], v[88:91]
  s_waitcnt vmcnt(14)
  s_barrier
  ds_read_b64_tr_b16 v[24:25], v12 offset:8192
  ds_read_b64_tr_b16 v[26:27], v12 offset:9216
  v_mfma_f32_32x32x16_bf16 v[120:135], v[44:47], v[76:79], v[120:135]
  ds_read_b64_tr_b16 v[28:29], v13 offset:8192
  ds_read_b64_tr_b16 v[30:31], v13 offset:9216
  ds_read_b64_tr_b16 v[32:33], v14 offset:8192
  v_mfma_f32_16x16x32_bf16 v[16:19], v[76:79], v[20:23], v[16:19]
  ds_read_b64_tr_b16 v[34:35], v14 offset:9216
  s_waitcnt lgkmcnt(6)
  v_mfma_f32_32x32x16_bf16 v[136:151], v[48:51], v[76:79], v[136:151]
  ds_read_b64_tr_b16 v[36:37], v15 offset:8192
  ds_read_b64_tr_b16 v[38:39], v15 offset:9216
  s_add_u32 m0, s12, 40960
  s_nop 0
  buffer_load_dwordx4 v6, s[48:51], s67 offen  lds
  v_mfma_f32_32x32x16_bf16 v[152:167], v[52:55], v[76:79], v[152:167]
  buffer_load_dwordx4 v7, s[48:51], s67 offen offset:1024  lds
  s_waitcnt lgkmcnt(4)
  v_mfma_f32_32x32x16_bf16 v[104:119], v[24:27], v[80:83], v[104:119]
  ds_read_b64_tr_b16 v[40:41], v12 offset:12288
  ds_read_b64_tr_b16 v[42:43], v12 offset:13312
  ds_read_b64_tr_b16 v[44:45], v13 offset:12288
  v_mfma_f32_16x16x32_bf16 v[88:91], v[24:27], v[20:23], v[88:91]
  ds_read_b64_tr_b16 v[46:47], v13 offset:13312
  v_mfma_f32_32x32x16_bf16 v[120:135], v[28:31], v[80:83], v[120:135]
  ds_read_b64_tr_b16 v[48:49], v14 offset:12288
  ds_read_b64_tr_b16 v[50:51], v14 offset:13312
  ds_read_b64_tr_b16 v[52:53], v15 offset:12288
  v_mfma_f32_16x16x32_bf16 v[16:19], v[80:83], v[20:23], v[16:19]
  ds_read_b64_tr_b16 v[54:55], v15 offset:13312
  s_waitcnt lgkmcnt(8)
  v_mfma_f32_32x32x16_bf16 v[136:151], v[32:35], v[80:83], v[136:151]
  v_mfma_f32_32x32x16_bf16 v[152:167], v[36:39], v[80:83], v[152:167]
  s_waitcnt lgkmcnt(4)
  v_mfma_f32_32x32x16_bf16 v[104:119], v[40:43], v[84:87], v[104:119]
  s_waitcnt vmcnt(10)
  ds_read_b128 v[56:59], v8 offset:0
  ds_read_b128 v[60:63], v9 offset:0
  v_mfma_f32_16x16x32_bf16 v[88:91], v[40:43], v[20:23], v[88:91]
  s_barrier
  ds_read_b64_tr_b16 v[24:25], v12 offset:16384
  ds_read_b64_tr_b16 v[26:27], v12 offset:17408
  v_mfma_f32_32x32x16_bf16 v[120:135], v[44:47], v[84:87], v[120:135]
  ds_read_b64_tr_b16 v[28:29], v13 offset:16384
  ds_read_b64_tr_b16 v[30:31], v13 offset:17408
  ds_read_b64_tr_b16 v[32:33], v14 offset:16384
  v_mfma_f32_16x16x32_bf16 v[16:19], v[84:87], v[20:23], v[16:19]
  ds_read_b64_tr_b16 v[34:35], v14 offset:17408
  s_waitcnt lgkmcnt(8)
  v_mfma_f32_32x32x16_bf16 v[136:151], v[48:51], v[84:87], v[136:151]
  ds_read_b64_tr_b16 v[36:37], v15 offset:16384
  ds_read_b64_tr_b16 v[38:39], v15 offset:17408
  ds_read_b128 v[64:67], v10 offset:0
  s_add_u32 m0, s12, 0
  s_nop 0
  buffer_load_dwordx4 v6, s[48:51], s68 offen  lds
  v_mfma_f32_32x32x16_bf16 v[152:167], v[52:55], v[84:87], v[152:167]
  ds_read_b128 v[68:71], v11 offset:0
  buffer_load_dwordx4 v7, s[48:51], s68 offen offset:1024  lds
  s_waitcnt lgkmcnt(11)
  s_waitcnt lgkmcnt(6)
  v_mfma_f32_32x32x16_bf16 v[104:119], v[24:27], v[56:59], v[104:119]
  ds_read_b64_tr_b16 v[40:41], v12 offset:20480
  ds_read_b64_tr_b16 v[42:43], v12 offset:21504
  ds_read_b64_tr_b16 v[44:45], v13 offset:20480
  v_mfma_f32_16x16x32_bf16 v[88:91], v[24:27], v[20:23], v[88:91]
  ds_read_b64_tr_b16 v[46:47], v13 offset:21504
  v_mfma_f32_32x32x16_bf16 v[120:135], v[28:31], v[56:59], v[120:135]
  ds_read_b64_tr_b16 v[48:49], v14 offset:20480
  ds_read_b64_tr_b16 v[50:51], v14 offset:21504
  ds_read_b64_tr_b16 v[52:53], v15 offset:20480
  v_mfma_f32_16x16x32_bf16 v[16:19], v[56:59], v[20:23], v[16:19]
  ds_read_b64_tr_b16 v[54:55], v15 offset:21504
  s_waitcnt lgkmcnt(10)
  v_mfma_f32_32x32x16_bf16 v[136:151], v[32:35], v[56:59], v[136:151]
  s_waitcnt lgkmcnt(8)
  s_add_u32 m0, s11, 0
  s_nop 0
  buffer_load_dwordx4 v2, s[44:47], s24 offen offset:0 lds
  buffer_load_dwordx4 v3, s[44:47], s24 offen offset:1024 lds
  v_mfma_f32_32x32x16_bf16 v[152:167], v[36:39], v[56:59], v[152:167]
  buffer_load_dwordx4 v4, s[44:47], s24 offen offset:2048 lds
  buffer_load_dwordx4 v5, s[44:47], s24 offen offset:3072 lds
  s_waitcnt lgkmcnt(4)
  v_mfma_f32_32x32x16_bf16 v[104:119], v[40:43], v[60:63], v[104:119]
  v_mfma_f32_16x16x32_bf16 v[88:91], v[40:43], v[20:23], v[88:91]
  s_waitcnt vmcnt(14)
  s_barrier
  ds_read_b64_tr_b16 v[24:25], v12 offset:24576
  ds_read_b64_tr_b16 v[26:27], v12 offset:25600
  v_mfma_f32_32x32x16_bf16 v[120:135], v[44:47], v[60:63], v[120:135]
  ds_read_b64_tr_b16 v[28:29], v13 offset:24576
  ds_read_b64_tr_b16 v[30:31], v13 offset:25600
  ds_read_b64_tr_b16 v[32:33], v14 offset:24576
  v_mfma_f32_16x16x32_bf16 v[16:19], v[60:63], v[20:23], v[16:19]
  ds_read_b64_tr_b16 v[34:35], v14 offset:25600
  s_waitcnt lgkmcnt(6)
  v_mfma_f32_32x32x16_bf16 v[136:151], v[48:51], v[60:63], v[136:151]
  ds_read_b64_tr_b16 v[36:37], v15 offset:24576
  ds_read_b64_tr_b16 v[38:39], v15 offset:25600
  s_add_u32 m0, s12, 8192
  s_nop 0
  buffer_load_dwordx4 v6, s[48:51], s69 offen  lds
  v_mfma_f32_32x32x16_bf16 v[152:167], v[52:55], v[60:63], v[152:167]
  buffer_load_dwordx4 v7, s[48:51], s69 offen offset:1024  lds
  s_waitcnt lgkmcnt(4)
  v_mfma_f32_32x32x16_bf16 v[104:119], v[24:27], v[64:67], v[104:119]
  ds_read_b64_tr_b16 v[40:41], v12 offset:28672
  ds_read_b64_tr_b16 v[42:43], v12 offset:29696
  ds_read_b64_tr_b16 v[44:45], v13 offset:28672
  v_mfma_f32_16x16x32_bf16 v[88:91], v[24:27], v[20:23], v[88:91]
  ds_read_b64_tr_b16 v[46:47], v13 offset:29696
  v_mfma_f32_32x32x16_bf16 v[120:135], v[28:31], v[64:67], v[120:135]
  ds_read_b64_tr_b16 v[48:49], v14 offset:28672
  ds_read_b64_tr_b16 v[50:51], v14 offset:29696
  ds_read_b64_tr_b16 v[52:53], v15 offset:28672
  v_mfma_f32_16x16x32_bf16 v[16:19], v[64:67], v[20:23], v[16:19]
  ds_read_b64_tr_b16 v[54:55], v15 offset:29696
  s_waitcnt lgkmcnt(8)
  v_mfma_f32_32x32x16_bf16 v[136:151], v[32:35], v[64:67], v[136:151]
  v_mfma_f32_32x32x16_bf16 v[152:167], v[36:39], v[64:67], v[152:167]
  s_waitcnt lgkmcnt(4)
  v_mfma_f32_32x32x16_bf16 v[104:119], v[40:43], v[68:71], v[104:119]
  s_waitcnt vmcnt(10)
  ds_read_b128 v[72:75], v8 offset:4096
  ds_read_b128 v[76:79], v9 offset:4096
  v_mfma_f32_16x16x32_bf16 v[88:91], v[40:43], v[20:23], v[88:91]
  s_barrier
  ds_read_b64_tr_b16 v[24:25], v12 offset:32768
  ds_read_b64_tr_b16 v[26:27], v12 offset:33792
  v_mfma_f32_32x32x16_bf16 v[120:135], v[44:47], v[68:71], v[120:135]
  ds_read_b64_tr_b16 v[28:29], v13 offset:32768
  ds_read_b64_tr_b16 v[30:31], v13 offset:33792
  ds_read_b64_tr_b16 v[32:33], v14 offset:32768
  v_mfma_f32_16x16x32_bf16 v[16:19], v[68:71], v[20:23], v[16:19]
  ds_read_b64_tr_b16 v[34:35], v14 offset:33792
  s_waitcnt lgkmcnt(8)
  v_mfma_f32_32x32x16_bf16 v[136:151], v[48:51], v[68:71], v[136:151]
  ds_read_b64_tr_b16 v[36:37], v15 offset:32768
  ds_read_b64_tr_b16 v[38:39], v15 offset:33792
  ds_read_b128 v[80:83], v10 offset:4096
  s_add_u32 m0, s12, 16384
  s_nop 0
  buffer_load_dwordx4 v6, s[48:51], s70 offen  lds
  v_mfma_f32_32x32x16_bf16 v[152:167], v[52:55], v[68:71], v[152:167]
  ds_read_b128 v[84:87], v11 offset:4096
  buffer_load_dwordx4 v7, s[48:51], s70 offen offset:1024  lds
  s_waitcnt lgkmcnt(11)
  s_waitcnt lgkmcnt(6)
  v_mfma_f32_32x32x16_bf16 v[104:119], v[24:27], v[72:75], v[104:119]
  ds_read_b64_tr_b16 v[40:41], v12 offset:36864
  ds_read_b64_tr_b16 v[42:43], v12 offset:37888
  ds_read_b64_tr_b16 v[44:45], v13 offset:36864
  v_mfma_f32_16x16x32_bf16 v[88:91], v[24:27], v[20:23], v[88:91]
  ds_read_b64_tr_b16 v[46:47], v13 offset:37888
  v_mfma_f32_32x32x16_bf16 v[120:135], v[28:31], v[72:75], v[120:135]
  ds_read_b64_tr_b16 v[48:49], v14 offset:36864
  ds_read_b64_tr_b16 v[50:51], v14 offset:37888
  ds_read_b64_tr_b16 v[52:53], v15 offset:36864
  v_mfma_f32_16x16x32_bf16 v[16:19], v[72:75], v[20:23], v[16:19]
  ds_read_b64_tr_b16 v[54:55], v15 offset:37888
  s_waitcnt lgkmcnt(10)
  v_mfma_f32_32x32x16_bf16 v[136:151], v[32:35], v[72:75], v[136:151]
  s_waitcnt lgkmcnt(8)
  s_add_u32 m0, s11, 4096
  s_nop 0
  buffer_load_dwordx4 v2, s[44:47], s25 offen offset:0 lds
  buffer_load_dwordx4 v3, s[44:47], s25 offen offset:1024 lds
  v_mfma_f32_32x32x16_bf16 v[152:167], v[36:39], v[72:75], v[152:167]
  buffer_load_dwordx4 v4, s[44:47], s25 offen offset:2048 lds
  buffer_load_dwordx4 v5, s[44:47], s25 offen offset:3072 lds
  s_waitcnt lgkmcnt(4)
  v_mfma_f32_32x32x16_bf16 v[104:119], v[40:43], v[76:79], v[104:119]
  v_mfma_f32_16x16x32_bf16 v[88:91], v[40:43], v[20:23], v[88:91]
  s_waitcnt vmcnt(14)
  s_barrier
  ds_read_b64_tr_b16 v[24:25], v12 offset:40960
  ds_read_b64_tr_b16 v[26:27], v12 offset:41984
  v_mfma_f32_32x32x16_bf16 v[120:135], v[44:47], v[76:79], v[120:135]
  ds_read_b64_tr_b16 v[28:29], v13 offset:40960
  ds_read_b64_tr_b16 v[30:31], v13 offset:41984
  ds_read_b64_tr_b16 v[32:33], v14 offset:40960
  v_mfma_f32_16x16x32_bf16 v[16:19], v[76:79], v[20:23], v[16:19]
  ds_read_b64_tr_b16 v[34:35], v14 offset:41984
  s_waitcnt lgkmcnt(6)
  v_mfma_f32_32x32x16_bf16 v[136:151], v[48:51], v[76:79], v[136:151]
  ds_read_b64_tr_b16 v[36:37], v15 offset:40960
  ds_read_b64_tr_b16 v[38:39], v15 offset:41984
  s_add_u32 m0, s12, 24576
  s_nop 0
  buffer_load_dwordx4 v6, s[48:51], s71 offen  lds
  v_mfma_f32_32x32x16_bf16 v[152:167], v[52:55], v[76:79], v[152:167]
  buffer_load_dwordx4 v7, s[48:51], s71 offen offset:1024  lds
  s_waitcnt lgkmcnt(4)
  v_mfma_f32_32x32x16_bf16 v[104:119], v[24:27], v[80:83], v[104:119]
  ds_read_b64_tr_b16 v[40:41], v12 offset:45056
  ds_read_b64_tr_b16 v[42:43], v12 offset:46080
  ds_read_b64_tr_b16 v[44:45], v13 offset:45056
  v_mfma_f32_16x16x32_bf16 v[88:91], v[24:27], v[20:23], v[88:91]
  ds_read_b64_tr_b16 v[46:47], v13 offset:46080
  v_mfma_f32_32x32x16_bf16 v[120:135], v[28:31], v[80:83], v[120:135]
  ds_read_b64_tr_b16 v[48:49], v14 offset:45056
  ds_read_b64_tr_b16 v[50:51], v14 offset:46080
  ds_read_b64_tr_b16 v[52:53], v15 offset:45056
  v_mfma_f32_16x16x32_bf16 v[16:19], v[80:83], v[20:23], v[16:19]
  ds_read_b64_tr_b16 v[54:55], v15 offset:46080
  s_waitcnt lgkmcnt(8)
  v_mfma_f32_32x32x16_bf16 v[136:151], v[32:35], v[80:83], v[136:151]
  v_mfma_f32_32x32x16_bf16 v[152:167], v[36:39], v[80:83], v[152:167]
  s_waitcnt lgkmcnt(4)
  v_mfma_f32_32x32x16_bf16 v[104:119], v[40:43], v[84:87], v[104:119]
  s_waitcnt vmcnt(10)
  ds_read_b128 v[56:59], v8 offset:0
  ds_read_b128 v[60:63], v9 offset:0
  v_mfma_f32_16x16x32_bf16 v[88:91], v[40:43], v[20:23], v[88:91]
  s_barrier
  ds_read_b64_tr_b16 v[24:25], v12 offset:0
  ds_read_b64_tr_b16 v[26:27], v12 offset:1024
  v_mfma_f32_32x32x16_bf16 v[120:135], v[44:47], v[84:87], v[120:135]
  ds_read_b64_tr_b16 v[28:29], v13 offset:0
  ds_read_b64_tr_b16 v[30:31], v13 offset:1024
  ds_read_b64_tr_b16 v[32:33], v14 offset:0
  v_mfma_f32_16x16x32_bf16 v[16:19], v[84:87], v[20:23], v[16:19]
  ds_read_b64_tr_b16 v[34:35], v14 offset:1024
  s_waitcnt lgkmcnt(8)
  v_mfma_f32_32x32x16_bf16 v[136:151], v[48:51], v[84:87], v[136:151]
  ds_read_b64_tr_b16 v[36:37], v15 offset:0
  ds_read_b64_tr_b16 v[38:39], v15 offset:1024
  ds_read_b128 v[64:67], v10 offset:0
  v_mfma_f32_32x32x16_bf16 v[152:167], v[52:55], v[84:87], v[152:167]
  ds_read_b128 v[68:71], v11 offset:0
  s_waitcnt lgkmcnt(11)
  s_waitcnt lgkmcnt(6)
  v_mfma_f32_32x32x16_bf16 v[104:119], v[24:27], v[56:59], v[104:119]
  ds_read_b64_tr_b16 v[40:41], v12 offset:4096
  ds_read_b64_tr_b16 v[42:43], v12 offset:5120
  ds_read_b64_tr_b16 v[44:45], v13 offset:4096
  v_mfma_f32_16x16x32_bf16 v[88:91], v[24:27], v[20:23], v[88:91]
  ds_read_b64_tr_b16 v[46:47], v13 offset:5120
  v_mfma_f32_32x32x16_bf16 v[120:135], v[28:31], v[56:59], v[120:135]
  ds_read_b64_tr_b16 v[48:49], v14 offset:4096
  ds_read_b64_tr_b16 v[50:51], v14 offset:5120
  ds_read_b64_tr_b16 v[52:53], v15 offset:4096
  v_mfma_f32_16x16x32_bf16 v[16:19], v[56:59], v[20:23], v[16:19]
  ds_read_b64_tr_b16 v[54:55], v15 offset:5120
  s_waitcnt lgkmcnt(10)
  v_mfma_f32_32x32x16_bf16 v[136:151], v[32:35], v[56:59], v[136:151]
  v_mfma_f32_32x32x16_bf16 v[152:167], v[36:39], v[56:59], v[152:167]
  s_waitcnt lgkmcnt(4)
  v_mfma_f32_32x32x16_bf16 v[104:119], v[40:43], v[60:63], v[104:119]
  v_mfma_f32_16x16x32_bf16 v[88:91], v[40:43], v[20:23], v[88:91]
  s_waitcnt vmcnt(8)
  s_barrier
  ds_read_b64_tr_b16 v[24:25], v12 offset:8192
  ds_read_b64_tr_b16 v[26:27], v12 offset:9216
  v_mfma_f32_32x32x16_bf16 v[120:135], v[44:47], v[60:63], v[120:135]
  ds_read_b64_tr_b16 v[28:29], v13 offset:8192
  ds_read_b64_tr_b16 v[30:31], v13 offset:9216
  ds_read_b64_tr_b16 v[32:33], v14 offset:8192
  v_mfma_f32_16x16x32_bf16 v[16:19], v[60:63], v[20:23], v[16:19]
  ds_read_b64_tr_b16 v[34:35], v14 offset:9216
  s_waitcnt lgkmcnt(6)
  v_mfma_f32_32x32x16_bf16 v[136:151], v[48:51], v[60:63], v[136:151]
  ds_read_b64_tr_b16 v[36:37], v15 offset:8192
  ds_read_b64_tr_b16 v[38:39], v15 offset:9216
  v_mfma_f32_32x32x16_bf16 v[152:167], v[52:55], v[60:63], v[152:167]
  s_waitcnt lgkmcnt(4)
  v_mfma_f32_32x32x16_bf16 v[104:119], v[24:27], v[64:67], v[104:119]
  ds_read_b64_tr_b16 v[40:41], v12 offset:12288
  ds_read_b64_tr_b16 v[42:43], v12 offset:13312
  ds_read_b64_tr_b16 v[44:45], v13 offset:12288
  v_mfma_f32_16x16x32_bf16 v[88:91], v[24:27], v[20:23], v[88:91]
  ds_read_b64_tr_b16 v[46:47], v13 offset:13312
  v_mfma_f32_32x32x16_bf16 v[120:135], v[28:31], v[64:67], v[120:135]
  ds_read_b64_tr_b16 v[48:49], v14 offset:12288
  ds_read_b64_tr_b16 v[50:51], v14 offset:13312
  ds_read_b64_tr_b16 v[52:53], v15 offset:12288
  v_mfma_f32_16x16x32_bf16 v[16:19], v[64:67], v[20:23], v[16:19]
  ds_read_b64_tr_b16 v[54:55], v15 offset:13312
  s_waitcnt lgkmcnt(8)
  v_mfma_f32_32x32x16_bf16 v[136:151], v[32:35], v[64:67], v[136:151]
  s_mov_b32 m0, s26
  s_nop 0
  buffer_load_dwordx4 v168, s[72:75], s30 offen offset:0 lds
  buffer_load_dwordx4 v169, s[72:75], s30 offen offset:1024 lds
  v_mfma_f32_32x32x16_bf16 v[152:167], v[36:39], v[64:67], v[152:167]
  buffer_load_dwordx4 v168, s[72:75], s30 offen offset:2048 lds
  buffer_load_dwordx4 v169, s[72:75], s30 offen offset:3072 lds
  s_add_u32 s30, s30, 32768
  s_cmp_eq_u32 s30, s31
  s_cselect_b32 s30, s81, s30
  s_waitcnt lgkmcnt(4)
  v_mfma_f32_32x32x16_bf16 v[104:119], v[40:43], v[68:71], v[104:119]
  s_waitcnt vmcnt(6)
  ds_read_b128 v[72:75], v8 offset:4096
  ds_read_b128 v[76:79], v9 offset:4096
  v_mfma_f32_16x16x32_bf16 v[88:91], v[40:43], v[20:23], v[88:91]
  s_barrier
  ds_read_b64_tr_b16 v[24:25], v12 offset:16384
  ds_read_b64_tr_b16 v[26:27], v12 offset:17408
  v_mfma_f32_32x32x16_bf16 v[120:135], v[44:47], v[68:71], v[120:135]
  ds_read_b64_tr_b16 v[28:29], v13 offset:16384
  ds_read_b64_tr_b16 v[30:31], v13 offset:17408
  ds_read_b64_tr_b16 v[32:33], v14 offset:16384
  v_mfma_f32_16x16x32_bf16 v[16:19], v[68:71], v[20:23], v[16:19]
  ds_read_b64_tr_b16 v[34:35], v14 offset:17408
  s_waitcnt lgkmcnt(8)
  v_mfma_f32_32x32x16_bf16 v[136:151], v[48:51], v[68:71], v[136:151]
  ds_read_b64_tr_b16 v[36:37], v15 offset:16384
  ds_read_b64_tr_b16 v[38:39], v15 offset:17408
  ds_read_b128 v[80:83], v10 offset:4096
  v_mfma_f32_32x32x16_bf16 v[152:167], v[52:55], v[68:71], v[152:167]
  ds_read_b128 v[84:87], v11 offset:4096
  s_waitcnt lgkmcnt(11)
  s_waitcnt lgkmcnt(6)
  v_mfma_f32_32x32x16_bf16 v[104:119], v[24:27], v[72:75], v[104:119]
  ds_read_b64_tr_b16 v[40:41], v12 offset:20480
  ds_read_b64_tr_b16 v[42:43], v12 offset:21504
  ds_read_b64_tr_b16 v[44:45], v13 offset:20480
  v_and_b32 v2, 15, v1
  v_lshrrev_b32 v3, 4, v1
  v_mfma_f32_16x16x32_bf16 v[88:91], v[24:27], v[20:23], v[88:91]
  ds_read_b64_tr_b16 v[46:47], v13 offset:21504
  v_lshlrev_b32 v3, 4, v3
  v_lshl_add_u32 v3, v2, 6, v3
  v_mfma_f32_32x32x16_bf16 v[120:135], v[28:31], v[72:75], v[120:135]
  ds_read_b64_tr_b16 v[48:49], v14 offset:20480
  ds_read_b64_tr_b16 v[50:51], v14 offset:21504
  ds_read_b64_tr_b16 v[52:53], v15 offset:20480
  s_lshl_b32 s13, s7, 7
  s_add_u32 s13, s13, 69632
  v_mfma_f32_16x16x32_bf16 v[16:19], v[72:75], v[20:23], v[16:19]
  ds_read_b64_tr_b16 v[54:55], v15 offset:21504
  v_add_u32 v3, s13, v3
  v_and_b32 v5, 31, v1
  s_waitcnt lgkmcnt(10)
  v_mfma_f32_32x32x16_bf16 v[136:151], v[32:35], v[72:75], v[136:151]
  v_lshl_add_u32 v5, v5, 2, s13
  v_lshrrev_b32 v2, 5, v1
  s_mov_b32 m0, s27
  s_nop 0
  buffer_load_dwordx4 v168, s[72:75], s30 offen offset:0 lds
  buffer_load_dwordx4 v169, s[72:75], s30 offen offset:1024 lds
  v_mfma_f32_32x32x16_bf16 v[152:167], v[36:39], v[72:75], v[152:167]
  v_lshlrev_b32 v2, 4, v2
  v_add_u32 v2, 69632, v2
  buffer_load_dwordx4 v168, s[72:75], s30 offen offset:2048 lds
  buffer_load_dwordx4 v169, s[72:75], s30 offen offset:3072 lds
  s_add_u32 s30, s30, 32768
  s_cmp_eq_u32 s30, s31
  s_cselect_b32 s30, s81, s30
  s_waitcnt lgkmcnt(4)
  v_mfma_f32_32x32x16_bf16 v[104:119], v[40:43], v[76:79], v[104:119]
  s_mul_i32 s14, s8, 112
  s_lshl_b32 s15, s42, 3
  v_mfma_f32_16x16x32_bf16 v[88:91], v[40:43], v[20:23], v[88:91]
  s_waitcnt vmcnt(8)
  s_barrier
  ds_read_b64_tr_b16 v[24:25], v12 offset:24576
  ds_read_b64_tr_b16 v[26:27], v12 offset:25600
  s_add_u32 s14, s14, s15
  s_lshl_b32 s14, s14, 10
  v_mfma_f32_32x32x16_bf16 v[120:135], v[44:47], v[76:79], v[120:135]
  ds_read_b64_tr_b16 v[28:29], v13 offset:24576
  ds_read_b64_tr_b16 v[30:31], v13 offset:25600
  ds_read_b64_tr_b16 v[32:33], v14 offset:24576
  v_lshlrev_b32 v4, 4, v1
  s_add_u32 s13, s7, 0
  v_mfma_f32_16x16x32_bf16 v[16:19], v[76:79], v[20:23], v[16:19]
  ds_read_b64_tr_b16 v[34:35], v14 offset:25600
  s_and_b32 s13, s13, 3
  s_lshl_b32 s68, s13, 11
  s_waitcnt lgkmcnt(6)
  v_mfma_f32_32x32x16_bf16 v[136:151], v[48:51], v[76:79], v[136:151]
  ds_read_b64_tr_b16 v[36:37], v15 offset:24576
  ds_read_b64_tr_b16 v[38:39], v15 offset:25600
  s_add_u32 s68, s68, s14
  s_lshl_b32 s13, s13, 7
  v_mfma_f32_32x32x16_bf16 v[152:167], v[52:55], v[76:79], v[152:167]
  v_add_u32 v8, s13, v2
  s_add_u32 s13, s7, 1
  s_waitcnt lgkmcnt(4)
  v_mfma_f32_32x32x16_bf16 v[104:119], v[24:27], v[80:83], v[104:119]
  ds_read_b64_tr_b16 v[40:41], v12 offset:28672
  ds_read_b64_tr_b16 v[42:43], v12 offset:29696
  ds_read_b64_tr_b16 v[44:45], v13 offset:28672
  s_and_b32 s13, s13, 3
  s_lshl_b32 s69, s13, 11
  v_mfma_f32_16x16x32_bf16 v[88:91], v[24:27], v[20:23], v[88:91]
  ds_read_b64_tr_b16 v[46:47], v13 offset:29696
  s_add_u32 s69, s69, s14
  s_lshl_b32 s13, s13, 7
  v_mfma_f32_32x32x16_bf16 v[120:135], v[28:31], v[80:83], v[120:135]
  ds_read_b64_tr_b16 v[48:49], v14 offset:28672
  ds_read_b64_tr_b16 v[50:51], v14 offset:29696
  ds_read_b64_tr_b16 v[52:53], v15 offset:28672
  v_add_u32 v9, s13, v2
  s_add_u32 s13, s7, 2
  v_mfma_f32_16x16x32_bf16 v[16:19], v[80:83], v[20:23], v[16:19]
  ds_read_b64_tr_b16 v[54:55], v15 offset:29696
  s_and_b32 s13, s13, 3
  s_lshl_b32 s70, s13, 11
  s_waitcnt lgkmcnt(8)
  v_mfma_f32_32x32x16_bf16 v[136:151], v[32:35], v[80:83], v[136:151]
  s_add_u32 s70, s70, s14
  s_lshl_b32 s13, s13, 7
  v_mfma_f32_32x32x16_bf16 v[152:167], v[36:39], v[80:83], v[152:167]
  v_add_u32 v10, s13, v2
  s_add_u32 s13, s7, 3
  s_waitcnt lgkmcnt(4)
  v_mfma_f32_32x32x16_bf16 v[104:119], v[40:43], v[84:87], v[104:119]
  s_and_b32 s13, s13, 3
  s_lshl_b32 s71, s13, 11
  s_add_u32 s71, s71, s14
  v_mfma_f32_16x16x32_bf16 v[88:91], v[40:43], v[20:23], v[88:91]
  s_lshl_b32 s13, s13, 7
  v_add_u32 v11, s13, v2
  v_mfma_f32_32x32x16_bf16 v[120:135], v[44:47], v[84:87], v[120:135]
  v_mfma_f32_16x16x32_bf16 v[16:19], v[84:87], v[20:23], v[16:19]
  s_waitcnt lgkmcnt(0)
  v_mfma_f32_32x32x16_bf16 v[136:151], v[48:51], v[84:87], v[136:151]
  v_mfma_f32_32x32x16_bf16 v[152:167], v[52:55], v[84:87], v[152:167]
  s_mov_b32 exec_lo, 0x00030003
  s_mov_b32 exec_hi, 0x00030003
  ds_write_b128 v3, v[88:91]
  s_nop 1
  ds_write_b128 v3, v[16:19] offset:512
  s_mov_b64 exec, -1
  s_waitcnt lgkmcnt(0)
  s_barrier
  ds_read_b32 v16, v5 offset:512
  ds_read_b128 v[24:27], v8 offset:0
  ds_read_b128 v[28:31], v8 offset:32
  ds_read_b128 v[32:35], v8 offset:64
  ds_read_b128 v[36:39], v8 offset:96
  ds_read_b128 v[40:43], v9 offset:0
  ds_read_b128 v[44:47], v9 offset:32
  ds_read_b128 v[48:51], v9 offset:64
  ds_read_b128 v[52:55], v9 offset:96
  ds_read_b128 v[56:59], v10 offset:0
  ds_read_b128 v[60:63], v10 offset:32
  ds_read_b128 v[64:67], v10 offset:64
  ds_read_b128 v[68:71], v10 offset:96
  ds_read_b128 v[72:75], v11 offset:0
  ds_read_b128 v[76:79], v11 offset:32
  ds_read_b128 v[80:83], v11 offset:64
  ds_read_b128 v[84:87], v11 offset:96
  s_waitcnt lgkmcnt(15)
  v_mul_f32 v16, 0x3b000000, v16
  v_cvt_pk_bf16_f32 v16, v16, v16
  v_lshlrev_b32 v16, 16, v16
  s_waitcnt lgkmcnt(12)
  v_pk_fma_f32 v[104:105], v[24:25], v[16:17], v[104:105] op_sel_hi:[1,0,1] neg_lo:[0,1,0] neg_hi:[0,1,0]
  v_pk_fma_f32 v[106:107], v[26:27], v[16:17], v[106:107] op_sel_hi:[1,0,1] neg_lo:[0,1,0] neg_hi:[0,1,0]
  v_pk_fma_f32 v[108:109], v[28:29], v[16:17], v[108:109] op_sel_hi:[1,0,1] neg_lo:[0,1,0] neg_hi:[0,1,0]
  v_pk_fma_f32 v[110:111], v[30:31], v[16:17], v[110:111] op_sel_hi:[1,0,1] neg_lo:[0,1,0] neg_hi:[0,1,0]
  v_cvt_pk_bf16_f32 v24, v104, v105
  v_cvt_pk_bf16_f32 v25, v106, v107
  v_cvt_pk_bf16_f32 v26, v108, v109
  v_cvt_pk_bf16_f32 v27, v110, v111
  v_pk_max_i16 v24, v24, 0
  v_pk_max_i16 v25, v25, 0
  v_pk_max_i16 v26, v26, 0
  v_pk_max_i16 v27, v27, 0
  buffer_store_dwordx4 v[24:27], v4, s[52:55], s68 offen offset:0 sc1
  v_pk_fma_f32 v[112:113], v[32:33], v[16:17], v[112:113] op_sel_hi:[1,0,1] neg_lo:[0,1,0] neg_hi:[0,1,0]
  v_pk_fma_f32 v[114:115], v[34:35], v[16:17], v[114:115] op_sel_hi:[1,0,1] neg_lo:[0,1,0] neg_hi:[0,1,0]
  v_pk_fma_f32 v[116:117], v[36:37], v[16:17], v[116:117] op_sel_hi:[1,0,1] neg_lo:[0,1,0] neg_hi:[0,1,0]
  v_pk_fma_f32 v[118:119], v[38:39], v[16:17], v[118:119] op_sel_hi:[1,0,1] neg_lo:[0,1,0] neg_hi:[0,1,0]
  v_cvt_pk_bf16_f32 v28, v112, v113
  v_cvt_pk_bf16_f32 v29, v114, v115
  v_cvt_pk_bf16_f32 v30, v116, v117
  v_cvt_pk_bf16_f32 v31, v118, v119
  v_pk_max_i16 v28, v28, 0
  v_pk_max_i16 v29, v29, 0
  v_pk_max_i16 v30, v30, 0
  v_pk_max_i16 v31, v31, 0
  buffer_store_dwordx4 v[28:31], v4, s[52:55], s68 offen offset:1024 sc1
  s_waitcnt lgkmcnt(8)
  v_pk_fma_f32 v[120:121], v[40:41], v[16:17], v[120:121] op_sel_hi:[1,0,1] neg_lo:[0,1,0] neg_hi:[0,1,0]
  v_pk_fma_f32 v[122:123], v[42:43], v[16:17], v[122:123] op_sel_hi:[1,0,1] neg_lo:[0,1,0] neg_hi:[0,1,0]
  v_pk_fma_f32 v[124:125], v[44:45], v[16:17], v[124:125] op_sel_hi:[1,0,1] neg_lo:[0,1,0] neg_hi:[0,1,0]
  v_pk_fma_f32 v[126:127], v[46:47], v[16:17], v[126:127] op_sel_hi:[1,0,1] neg_lo:[0,1,0] neg_hi:[0,1,0]
  v_cvt_pk_bf16_f32 v40, v120, v121
  v_cvt_pk_bf16_f32 v41, v122, v123
  v_cvt_pk_bf16_f32 v42, v124, v125
  v_cvt_pk_bf16_f32 v43, v126, v127
  v_pk_max_i16 v40, v40, 0
  v_pk_max_i16 v41, v41, 0
  v_pk_max_i16 v42, v42, 0
  v_pk_max_i16 v43, v43, 0
  buffer_store_dwordx4 v[40:43], v4, s[52:55], s69 offen offset:0 sc1
  v_pk_fma_f32 v[128:129], v[48:49], v[16:17], v[128:129] op_sel_hi:[1,0,1] neg_lo:[0,1,0] neg_hi:[0,1,0]
  v_pk_fma_f32 v[130:131], v[50:51], v[16:17], v[130:131] op_sel_hi:[1,0,1] neg_lo:[0,1,0] neg_hi:[0,1,0]
  v_pk_fma_f32 v[132:133], v[52:53], v[16:17], v[132:133] op_sel_hi:[1,0,1] neg_lo:[0,1,0] neg_hi:[0,1,0]
  v_pk_fma_f32 v[134:135], v[54:55], v[16:17], v[134:135] op_sel_hi:[1,0,1] neg_lo:[0,1,0] neg_hi:[0,1,0]
  v_cvt_pk_bf16_f32 v44, v128, v129
  v_cvt_pk_bf16_f32 v45, v130, v131
  v_cvt_pk_bf16_f32 v46, v132, v133
  v_cvt_pk_bf16_f32 v47, v134, v135
  v_pk_max_i16 v44, v44, 0
  v_pk_max_i16 v45, v45, 0
  v_pk_max_i16 v46, v46, 0
  v_pk_max_i16 v47, v47, 0
  buffer_store_dwordx4 v[44:47], v4, s[52:55], s69 offen offset:1024 sc1
  s_waitcnt lgkmcnt(4)
  v_pk_fma_f32 v[136:137], v[56:57], v[16:17], v[136:137] op_sel_hi:[1,0,1] neg_lo:[0,1,0] neg_hi:[0,1,0]
  v_pk_fma_f32 v[138:139], v[58:59], v[16:17], v[138:139] op_sel_hi:[1,0,1] neg_lo:[0,1,0] neg_hi:[0,1,0]
  v_pk_fma_f32 v[140:141], v[60:61], v[16:17], v[140:141] op_sel_hi:[1,0,1] neg_lo:[0,1,0] neg_hi:[0,1,0]
  v_pk_fma_f32 v[142:143], v[62:63], v[16:17], v[142:143] op_sel_hi:[1,0,1] neg_lo:[0,1,0] neg_hi:[0,1,0]
  v_cvt_pk_bf16_f32 v56, v136, v137
  v_cvt_pk_bf16_f32 v57, v138, v139
  v_cvt_pk_bf16_f32 v58, v140, v141
  v_cvt_pk_bf16_f32 v59, v142, v143
  v_pk_max_i16 v56, v56, 0
  v_pk_max_i16 v57, v57, 0
  v_pk_max_i16 v58, v58, 0
  v_pk_max_i16 v59, v59, 0
  buffer_store_dwordx4 v[56:59], v4, s[52:55], s70 offen offset:0 sc1
  v_pk_fma_f32 v[144:145], v[64:65], v[16:17], v[144:145] op_sel_hi:[1,0,1] neg_lo:[0,1,0] neg_hi:[0,1,0]
  v_pk_fma_f32 v[146:147], v[66:67], v[16:17], v[146:147] op_sel_hi:[1,0,1] neg_lo:[0,1,0] neg_hi:[0,1,0]
  v_pk_fma_f32 v[148:149], v[68:69], v[16:17], v[148:149] op_sel_hi:[1,0,1] neg_lo:[0,1,0] neg_hi:[0,1,0]
  v_pk_fma_f32 v[150:151], v[70:71], v[16:17], v[150:151] op_sel_hi:[1,0,1] neg_lo:[0,1,0] neg_hi:[0,1,0]
  v_cvt_pk_bf16_f32 v60, v144, v145
  v_cvt_pk_bf16_f32 v61, v146, v147
  v_cvt_pk_bf16_f32 v62, v148, v149
  v_cvt_pk_bf16_f32 v63, v150, v151
  v_pk_max_i16 v60, v60, 0
  v_pk_max_i16 v61, v61, 0
  v_pk_max_i16 v62, v62, 0
  v_pk_max_i16 v63, v63, 0
  buffer_store_dwordx4 v[60:63], v4, s[52:55], s70 offen offset:1024 sc1
  s_waitcnt lgkmcnt(0)
  v_pk_fma_f32 v[152:153], v[72:73], v[16:17], v[152:153] op_sel_hi:[1,0,1] neg_lo:[0,1,0] neg_hi:[0,1,0]
  v_pk_fma_f32 v[154:155], v[74:75], v[16:17], v[154:155] op_sel_hi:[1,0,1] neg_lo:[0,1,0] neg_hi:[0,1,0]
  v_pk_fma_f32 v[156:157], v[76:77], v[16:17], v[156:157] op_sel_hi:[1,0,1] neg_lo:[0,1,0] neg_hi:[0,1,0]
  v_pk_fma_f32 v[158:159], v[78:79], v[16:17], v[158:159] op_sel_hi:[1,0,1] neg_lo:[0,1,0] neg_hi:[0,1,0]
  v_cvt_pk_bf16_f32 v72, v152, v153
  v_cvt_pk_bf16_f32 v73, v154, v155
  v_cvt_pk_bf16_f32 v74, v156, v157
  v_cvt_pk_bf16_f32 v75, v158, v159
  v_pk_max_i16 v72, v72, 0
  v_pk_max_i16 v73, v73, 0
  v_pk_max_i16 v74, v74, 0
  v_pk_max_i16 v75, v75, 0
  buffer_store_dwordx4 v[72:75], v4, s[52:55], s71 offen offset:0 sc1
  v_pk_fma_f32 v[160:161], v[80:81], v[16:17], v[160:161] op_sel_hi:[1,0,1] neg_lo:[0,1,0] neg_hi:[0,1,0]
  v_pk_fma_f32 v[162:163], v[82:83], v[16:17], v[162:163] op_sel_hi:[1,0,1] neg_lo:[0,1,0] neg_hi:[0,1,0]
  v_pk_fma_f32 v[164:165], v[84:85], v[16:17], v[164:165] op_sel_hi:[1,0,1] neg_lo:[0,1,0] neg_hi:[0,1,0]
  v_pk_fma_f32 v[166:167], v[86:87], v[16:17], v[166:167] op_sel_hi:[1,0,1] neg_lo:[0,1,0] neg_hi:[0,1,0]
  v_cvt_pk_bf16_f32 v76, v160, v161
  v_cvt_pk_bf16_f32 v77, v162, v163
  v_cvt_pk_bf16_f32 v78, v164, v165
  v_cvt_pk_bf16_f32 v79, v166, v167
  v_pk_max_i16 v76, v76, 0
  v_pk_max_i16 v77, v77, 0
  v_pk_max_i16 v78, v78, 0
  v_pk_max_i16 v79, v79, 0
  buffer_store_dwordx4 v[76:79], v4, s[52:55], s71 offen offset:1024 sc1
  s_lshl_b32 s83, s43, 11
  s_lshl_b32 s13, s42, 7
  s_add_u32 s83, s83, s13
  s_branch Lg2
Ltouch:
  s_sub_u32 s5, s4, 28
  s_lshl_b32 s5, s5, 2
  s_add_u32 s5, s5, s7
  s_mul_i32 s6, s5, 114688
  v_lshlrev_b32 v2, 7, v1
  v_lshlrev_b32 v4, 18, v1
  s_waitcnt lgkmcnt(0)
  s_cmp_lg_u32 s2, 224
  s_cbranch_scc1 Lnotag_1
  s_cmp_lg_u32 s7, 0
  s_cbranch_scc1 Lnotag_1
  s_mov_b32 s44, s38
  s_and_b32 s45, s39, 0xffff
  s_mov_b32 s46, 256
  s_mov_b32 s47, 0x20000
  s_memrealtime s[8:9]
  s_waitcnt lgkmcnt(0)
  s_or_b32 s8, s8, 1
  v_mov_b32 v3, s8
  s_mov_b64 exec, 1
  buffer_store_dword v3, off, s[44:47], 0 sc1
  s_mov_b64 exec, -1
Lnotag_1:
  s_mov_b32 s52, s40
  s_and_b32 s53, s41, 0xffff
  s_mov_b32 s54, 13631488
  s_mov_b32 s55, 0x20000
  s_mov_b32 s44, s36
  s_and_b32 s45, s37, 0xffff
  s_mov_b32 s46, 2097152
  s_mov_b32 s47, 0x20000
  buffer_load_dword v247, v4, s[52:55], 0 offen sc1
  buffer_load_dword v247, v4, s[44:47], 0 offen sc1
  s_mul_i32 s85, s5, 65536
  s_mov_b32 s52, s40
  s_and_b32 s53, s41, 0xffff
  s_mov_b32 s54, 7340032
  s_mov_b32 s55, 0x20000
  s_mov_b32 s44, s16
  s_and_b32 s45, s17, 0xffff
  s_mov_b32 s46, 2097152
  s_mov_b32 s47, 0x20000
  s_mov_b32 s72, s34
  s_and_b32 s73, s35, 0xffff
  s_mov_b32 s74, 1835008
  s_mov_b32 s75, 0x20000
  s_and_b32 s80, s4, 7
  s_mul_i32 s85, s80, 0
  s_lshr_b32 s30, s4, 3
  s_mul_i32 s30, s30, 28
  s_add_u32 s85, s85, s30
  s_mul_i32 s30, s3, 14
  s_add_u32 s85, s85, s30
  s_lshr_b32 s85, s85, 3
  s_cmp_ge_u32 s85, 14
  s_cselect_b32 s30, 14, 0
  s_sub_u32 s85, s85, s30
  s_cmp_ge_u32 s85, 14
  s_cselect_b32 s30, 14, 0
  s_sub_u32 s85, s85, s30
  s_lshl_b32 s30, s85, 15
  s_mul_i32 s81, s7, 458752
  s_lshl_b32 s80, s80, 7
  s_add_u32 s81, s81, s80
  s_add_u32 s31, s81, 458752
  s_add_u32 s30, s30, s81
  s_lshl_b32 s26, s7, 13
  s_add_u32 s26, s26, 49152
  s_lshl_b32 s27, s7, 12
  s_add_u32 s27, s27, 32768
  s_lshl_b32 s28, s7, 12
  s_add_u32 s28, s28, 0
  s_lshl_b32 s29, s7, 13
  s_add_u32 s29, s29, 53248
  v_lshrrev_b32 v168, 3, v1
  v_lshlrev_b32 v168, 12, v168
  v_and_b32 v169, 7, v1
  v_lshl_add_u32 v168, v169, 4, v168
  v_xor_b32 v169, 64, v168
  s_mov_b32 m0, s26
  s_nop 0
  buffer_load_dwordx4 v168, s[72:75], s30 offen offset:0 lds
  buffer_load_dwordx4 v169, s[72:75], s30 offen offset:1024 lds
  buffer_load_dwordx4 v168, s[72:75], s30 offen offset:2048 lds
  buffer_load_dwordx4 v169, s[72:75], s30 offen offset:3072 lds
  s_add_u32 s30, s30, 32768
  s_cmp_eq_u32 s30, s31
  s_cselect_b32 s30, s81, s30
  s_mov_b32 m0, s27
  s_nop 0
  buffer_load_dwordx4 v168, s[72:75], s30 offen offset:0 lds
  buffer_load_dwordx4 v169, s[72:75], s30 offen offset:1024 lds
  buffer_load_dwordx4 v168, s[72:75], s30 offen offset:2048 lds
  buffer_load_dwordx4 v169, s[72:75], s30 offen offset:3072 lds
  s_add_u32 s30, s30, 32768
  s_cmp_eq_u32 s30, s31
  s_cselect_b32 s30, s81, s30
  s_mov_b32 s83, -1
Lg2:
  s_mov_b32 s68, s38
  s_and_b32 s69, s39, 0xffff
  s_mov_b32 s70, 256
  s_mov_b32 s71, 0x20000
  buffer_load_dword v10, off, s[68:71], 0 sc1
  s_lshr_b32 s5, s4, 3
  s_lshl_b32 s6, s3, 2
  s_add_u32 s5, s5, s6
  s_and_b32 s4, s4, 7
  s_mov_b32 s6, s85
  v_mov_b32 v2, v168
  v_mov_b32 v3, v169
  s_mov_b32 s8, s81
  s_mul_i32 s10, s7, 17408
  v_lshlrev_b32 v4, 4, v1
  v_add_u32 v5, 114688, v4
  s_mul_i32 s9, s5, 224
  s_mul_i32 s12, s7, 28
  s_add_u32 s9, s9, s12
  s_lshl_b32 s9, s9, 10
  s_add_u32 s15, s9, 28672
  s_lshl_b32 s12, s6, 11
  s_add_u32 s12, s12, s9
  v_bfe_u32 v14, v1, 2, 2
  v_lshrrev_b32 v11, 5, v1
  v_lshlrev_b32 v11, 7, v11
  v_lshl_add_u32 v11, v14, 10, v11
  v_and_b32 v12, 1, v1
  v_lshl_add_u32 v11, v12, 3, v11
  v_bfe_u32 v12, v1, 4, 1
  v_bfe_u32 v13, v1, 1, 1
  v_lshl_add_u32 v12, v12, 1, v13
  v_lshl_add_u32 v11, v12, 4, v11
  v_and_b32 v14, 1, v14
  v_lshl_add_u32 v11, v14, 6, v11
  s_lshl_b32 s13, s7, 13
  v_add_u32 v6, s13, v11
  v_xor_b32 v7, 64, v6
  s_lshl_b32 s13, s7, 12
  v_add_u32 v20, s13, v11
  v_xor_b32 v21, 64, v20
  s_add_u32 s76, s40, 12648448
  s_addc_u32 s77, s41, 0
  s_and_b32 s77, s77, 0xffff
  s_mov_b32 s78, 131072
  s_mov_b32 s79, 0x20000
  s_mov_b32 s13, 0
  s_waitcnt vmcnt(0)
Lep_2:
  v_readfirstlane_b32 s82, v10
  s_add_u32 s13, s13, 1
  s_cmp_eq_u32 s82, 0
  s_cbranch_scc1 Lepr_4
  s_sub_u32 vcc_lo, s82, s84
  s_cmp_gt_i32 vcc_lo, -1000
  s_cbranch_scc1 Lepd_3
Lepr_4:
  s_cmp_gt_u32 s13, 65536
  s_cbranch_scc1 Lepd_3
  s_sleep 4
  buffer_load_dword v10, off, s[68:71], 0 sc1
  s_waitcnt vmcnt(0)
  s_branch Lep_2
Lepd_3:
  s_barrier
  s_cmp_eq_u32 s83, -1
  s_cbranch_scc1 Lnofl_5
  s_cmp_lg_u32 s7, 0
  s_cbranch_scc1 Lsf_6
  v_mov_b32 v11, s82
  s_mov_b64 exec, 1
  buffer_store_dword v11, off, s[76:79], s83 sc1
  s_mov_b64 exec, -1
Lsf_6:
Lnofl_5:
  s_setprio 0
  ds_read_b64_tr_b16 v[24:25], v6 offset:49152
  ds_read_b64_tr_b16 v[26:27], v6 offset:49408
  ds_read_b64_tr_b16 v[28:29], v7 offset:49152
  ds_read_b64_tr_b16 v[30:31], v7 offset:49408
  ds_read_b64_tr_b16 v[32:33], v6 offset:49664
  ds_read_b64_tr_b16 v[34:35], v6 offset:49920
  ds_read_b64_tr_b16 v[36:37], v7 offset:49664
  ds_read_b64_tr_b16 v[38:39], v7 offset:49920
  ds_read_b64_tr_b16 v[40:41], v20 offset:32768
  ds_read_b64_tr_b16 v[42:43], v20 offset:33024
  ds_read_b64_tr_b16 v[44:45], v21 offset:32768
  ds_read_b64_tr_b16 v[46:47], v21 offset:33024
  ds_read_b64_tr_b16 v[48:49], v20 offset:33280
  ds_read_b64_tr_b16 v[50:51], v20 offset:33536
  ds_read_b64_tr_b16 v[52:53], v21 offset:33280
  ds_read_b64_tr_b16 v[54:55], v21 offset:33536
  s_mov_b32 m0, s28
  s_nop 0
  buffer_load_dwordx4 v2, s[72:75], s30 offen offset:0 lds
  buffer_load_dwordx4 v3, s[72:75], s30 offen offset:1024 lds
  buffer_load_dwordx4 v2, s[72:75], s30 offen offset:2048 lds
  buffer_load_dwordx4 v3, s[72:75], s30 offen offset:3072 lds
  s_add_u32 s30, s30, 32768
  s_cmp_eq_u32 s30, s31
  s_cselect_b32 s30, s81, s30
  s_mov_b32 m0, s29
  s_nop 0
  buffer_load_dwordx4 v2, s[72:75], s30 offen offset:0 lds
  buffer_load_dwordx4 v3, s[72:75], s30 offen offset:1024 lds
  buffer_load_dwordx4 v2, s[72:75], s30 offen offset:2048 lds
  buffer_load_dwordx4 v3, s[72:75], s30 offen offset:3072 lds
  s_add_u32 s30, s30, 32768
  s_cmp_eq_u32 s30, s31
  s_cselect_b32 s30, s81, s30
  s_waitcnt lgkmcnt(8)
  s_mov_b32 m0, s26
  s_nop 0
  buffer_load_dwordx4 v2, s[72:75], s30 offen offset:0 lds
  buffer_load_dwordx4 v3, s[72:75], s30 offen offset:1024 lds
  buffer_load_dwordx4 v2, s[72:75], s30 offen offset:2048 lds
  buffer_load_dwordx4 v3, s[72:75], s30 offen offset:3072 lds
  s_add_u32 s30, s30, 32768
  s_cmp_eq_u32 s30, s31
  s_cselect_b32 s30, s81, s30
  s_waitcnt lgkmcnt(0)
  s_mov_b32 m0, s27
  s_nop 0
  buffer_load_dwordx4 v2, s[72:75], s30 offen offset:0 lds
  buffer_load_dwordx4 v3, s[72:75], s30 offen offset:1024 lds
  buffer_load_dwordx4 v2, s[72:75], s30 offen offset:2048 lds
  buffer_load_dwordx4 v3, s[72:75], s30 offen offset:3072 lds
  s_add_u32 s30, s30, 32768
  s_cmp_eq_u32 s30, s31
  s_cselect_b32 s30, s81, s30
  s_mov_b32 s56, s36
  s_and_b32 s57, s37, 0xffff
  s_mov_b32 s58, 2097152
  s_mov_b32 s59, 0x20000
  s_add_u32 s60, s40, 10485760
  s_addc_u32 s61, s41, 0
  s_and_b32 s61, s61, 0xffff
  s_mov_b32 s62, 2097152
  s_mov_b32 s63, 0x20000
  s_add_u32 s64, s40, 12582912
  s_addc_u32 s65, s41, 0
  s_and_b32 s65, s65, 0xffff
  s_mov_b32 s66, 8192
  s_mov_b32 s67, 0x20000
  v_and_b32 v10, 15, v1
  v_lshrrev_b32 v11, 4, v1
  v_lshlrev_b32 v8, 10, v10
  v_lshl_add_u32 v8, v11, 4, v8
  v_lshlrev_b32 v22, 2, v10
  s_lshl_b32 s13, s5, 2
  s_add_u32 s13, s13, s7
  s_lshl_b32 s42, s13, 6
  s_lshl_b32 s13, s13, 14
  s_lshl_b32 s43, s4, 7
  s_add_u32 s13, s13, s43
  s_waitcnt vmcnt(12)
  ds_read_b64_tr_b16 v[56:57], v20 offset:0
  ds_read_b64_tr_b16 v[58:59], v20 offset:256
  ds_read_b64_tr_b16 v[60:61], v21 offset:0
  ds_read_b64_tr_b16 v[62:63], v21 offset:256
  ds_read_b64_tr_b16 v[64:65], v20 offset:512
  ds_read_b64_tr_b16 v[66:67], v20 offset:768
  ds_read_b64_tr_b16 v[68:69], v21 offset:512
  ds_read_b64_tr_b16 v[70:71], v21 offset:768
  s_waitcnt lgkmcnt(0)
  s_mov_b32 m0, s28
  s_nop 0
  buffer_load_dwordx4 v2, s[72:75], s30 offen offset:0 lds
  buffer_load_dwordx4 v3, s[72:75], s30 offen offset:1024 lds
  buffer_load_dwordx4 v2, s[72:75], s30 offen offset:2048 lds
  buffer_load_dwordx4 v3, s[72:75], s30 offen offset:3072 lds
  s_add_u32 s30, s30, 32768
  s_cmp_eq_u32 s30, s31
  s_cselect_b32 s30, s81, s30
  s_waitcnt vmcnt(12)
  ds_read_b64_tr_b16 v[72:73], v6 offset:53248
  ds_read_b64_tr_b16 v[74:75], v6 offset:53504
  ds_read_b64_tr_b16 v[76:77], v7 offset:53248
  ds_read_b64_tr_b16 v[78:79], v7 offset:53504
  ds_read_b64_tr_b16 v[80:81], v6 offset:53760
  ds_read_b64_tr_b16 v[82:83], v6 offset:54016
  ds_read_b64_tr_b16 v[84:85], v7 offset:53760
  ds_read_b64_tr_b16 v[86:87], v7 offset:54016
  s_waitcnt lgkmcnt(0)
  s_mov_b32 m0, s29
  s_nop 0
  buffer_load_dwordx4 v2, s[72:75], s30 offen offset:0 lds
  buffer_load_dwordx4 v3, s[72:75], s30 offen offset:1024 lds
  buffer_load_dwordx4 v2, s[72:75], s30 offen offset:2048 lds
  buffer_load_dwordx4 v3, s[72:75], s30 offen offset:3072 lds
  s_add_u32 s30, s30, 32768
  s_cmp_eq_u32 s30, s31
  s_cselect_b32 s30, s81, s30
  s_waitcnt vmcnt(12)
  ds_read_b64_tr_b16 v[88:89], v6 offset:49152
  ds_read_b64_tr_b16 v[90:91], v6 offset:49408
  ds_read_b64_tr_b16 v[92:93], v7 offset:49152
  ds_read_b64_tr_b16 v[94:95], v7 offset:49408
  ds_read_b64_tr_b16 v[96:97], v6 offset:49664
  ds_read_b64_tr_b16 v[98:99], v6 offset:49920
  ds_read_b64_tr_b16 v[100:101], v7 offset:49664
  ds_read_b64_tr_b16 v[102:103], v7 offset:49920
  s_waitcnt lgkmcnt(0)
  s_mov_b32 m0, s26
  s_nop 0
  buffer_load_dwordx4 v2, s[72:75], s30 offen offset:0 lds
  buffer_load_dwordx4 v3, s[72:75], s30 offen offset:1024 lds
  buffer_load_dwordx4 v2, s[72:75], s30 offen offset:2048 lds
  buffer_load_dwordx4 v3, s[72:75], s30 offen offset:3072 lds
  s_add_u32 s30, s30, 32768
  s_cmp_eq_u32 s30, s31
  s_cselect_b32 s30, s81, s30
  s_waitcnt vmcnt(12)
  ds_read_b64_tr_b16 v[104:105], v20 offset:32768
  ds_read_b64_tr_b16 v[106:107], v20 offset:33024
  ds_read_b64_tr_b16 v[108:109], v21 offset:32768
  ds_read_b64_tr_b16 v[110:111], v21 offset:33024
  ds_read_b64_tr_b16 v[112:113], v20 offset:33280
  ds_read_b64_tr_b16 v[114:115], v20 offset:33536
  ds_read_b64_tr_b16 v[116:117], v21 offset:33280
  ds_read_b64_tr_b16 v[118:119], v21 offset:33536
  s_waitcnt lgkmcnt(0)
  s_mov_b32 m0, s27
  s_nop 0
  buffer_load_dwordx4 v2, s[72:75], s30 offen offset:0 lds
  buffer_load_dwordx4 v3, s[72:75], s30 offen offset:1024 lds
  buffer_load_dwordx4 v2, s[72:75], s30 offen offset:2048 lds
  buffer_load_dwordx4 v3, s[72:75], s30 offen offset:3072 lds
  s_add_u32 s30, s30, 32768
  s_cmp_eq_u32 s30, s31
  s_cselect_b32 s30, s81, s30
  buffer_load_dwordx4 v[12:15], v8, s[44:47], s13 offen offset:0
  buffer_load_dwordx4 v[16:19], v8, s[44:47], s13 offen offset:64
  s_cmp_lg_u32 s83, -1
  s_cbranch_scc1 Lnot_7
  v_lshlrev_b32 v10, 10, v1
  s_mov_b32 s85, s8
  buffer_load_dword v11, v10, s[72:75], s85 offen
  s_add_u32 s85, s85, 65536
  buffer_load_dword v11, v10, s[72:75], s85 offen
  s_add_u32 s85, s85, 65536
  buffer_load_dword v11, v10, s[72:75], s85 offen
  s_add_u32 s85, s85, 65536
  buffer_load_dword v11, v10, s[72:75], s85 offen
  s_add_u32 s85, s85, 65536
  s_waitcnt vmcnt(3)
  buffer_load_dword v11, v10, s[72:75], s85 offen
  s_add_u32 s85, s85, 65536
  s_waitcnt vmcnt(3)
  buffer_load_dword v11, v10, s[72:75], s85 offen
  s_add_u32 s85, s85, 65536
  s_waitcnt vmcnt(3)
  buffer_load_dword v11, v10, s[72:75], s85 offen
  s_add_u32 s85, s85, 65536
  s_waitcnt vmcnt(0)
Lnot_7:
  v_min_u32 v10, 13, v1
  v_lshlrev_b32 v10, 7, v10
  s_lshr_b32 s43, s5, 1
  s_lshl_b32 s43, s43, 11
  s_mov_b32 s6, 0
  s_cmp_lg_u32 s7, 0
  s_cbranch_scc1 Lpld_9
Lpl_8:
  buffer_load_dword v11, v10, s[76:79], s43 offen sc1
  s_add_u32 s6, s6, 1
  s_waitcnt vmcnt(0)
  v_cmp_ne_u32 vcc, s82, v11
  s_cbranch_vccz Lpld_9
  s_cmp_gt_u32 s6, 65536
  s_cbranch_scc1 Lpld_9
  s_sleep 8
  s_branch Lpl_8
Lpld_9:
  s_barrier
  buffer_load_dwordx4 v[184:187], v4, s[52:55], s12 offen offset:0 sc1
  buffer_load_dwordx4 v[188:191], v5, s[52:55], s12 offen offset:0 sc1
  buffer_load_dwordx4 v[192:195], v4, s[52:55], s12 offen offset:1024 sc1
  buffer_load_dwordx4 v[196:199], v5, s[52:55], s12 offen offset:1024 sc1
  s_add_u32 s12, s12, 2048
  s_cmp_eq_u32 s12, s15
  s_cselect_b32 s12, s9, s12
  buffer_load_dwordx4 v[200:203], v4, s[52:55], s12 offen offset:0 sc1
  buffer_load_dwordx4 v[204:207], v5, s[52:55], s12 offen offset:0 sc1
  buffer_load_dwordx4 v[208:211], v4, s[52:55], s12 offen offset:1024 sc1
  buffer_load_dwordx4 v[212:215], v5, s[52:55], s12 offen offset:1024 sc1
  s_add_u32 s12, s12, 2048
  s_cmp_eq_u32 s12, s15
  s_cselect_b32 s12, s9, s12
  buffer_load_dwordx4 v[216:219], v4, s[52:55], s12 offen offset:0 sc1
  buffer_load_dwordx4 v[220:223], v5, s[52:55], s12 offen offset:0 sc1
  buffer_load_dwordx4 v[224:227], v4, s[52:55], s12 offen offset:1024 sc1
  buffer_load_dwordx4 v[228:231], v5, s[52:55], s12 offen offset:1024 sc1
  s_add_u32 s12, s12, 2048
  s_cmp_eq_u32 s12, s15
  s_cselect_b32 s12, s9, s12
  buffer_load_dwordx4 v[232:235], v4, s[52:55], s12 offen offset:0 sc1
  buffer_load_dwordx4 v[236:239], v5, s[52:55], s12 offen offset:0 sc1
  buffer_load_dwordx4 v[240:243], v4, s[52:55], s12 offen offset:1024 sc1
  buffer_load_dwordx4 v[244:247], v5, s[52:55], s12 offen offset:1024 sc1
  s_add_u32 s12, s12, 2048
  s_cmp_eq_u32 s12, s15
  s_cselect_b32 s12, s9, s12
  s_waitcnt vmcnt(12)
  v_mfma_f32_32x32x16_bf16 v[120:135], v[24:27], v[184:187], 0
  v_mfma_f32_32x32x16_bf16 v[136:151], v[24:27], v[188:191], 0
  v_mfma_f32_32x32x16_bf16 v[152:167], v[28:31], v[184:187], 0
  v_mfma_f32_32x32x16_bf16 v[168:183], v[28:31], v[188:191], 0
  v_mfma_f32_32x32x16_bf16 v[120:135], v[32:35], v[192:195], v[120:135]
  buffer_load_dwordx4 v[184:187], v4, s[52:55], s12 offen offset:0 sc1
  v_mfma_f32_32x32x16_bf16 v[136:151], v[32:35], v[196:199], v[136:151]
  buffer_load_dwordx4 v[188:191], v5, s[52:55], s12 offen offset:0 sc1
  v_mfma_f32_32x32x16_bf16 v[152:167], v[36:39], v[192:195], v[152:167]
  v_mfma_f32_32x32x16_bf16 v[168:183], v[36:39], v[196:199], v[168:183]
  buffer_load_dwordx4 v[192:195], v4, s[52:55], s12 offen offset:1024 sc1
  buffer_load_dwordx4 v[196:199], v5, s[52:55], s12 offen offset:1024 sc1
  s_add_u32 s12, s12, 2048
  s_cmp_eq_u32 s12, s15
  s_cselect_b32 s12, s9, s12
  s_waitcnt vmcnt(12)
  v_mfma_f32_32x32x16_bf16 v[120:135], v[40:43], v[200:203], v[120:135]
  ds_read_b64_tr_b16 v[24:25], v20 offset:0
  ds_read_b64_tr_b16 v[26:27], v20 offset:256
  v_mfma_f32_32x32x16_bf16 v[136:151], v[40:43], v[204:207], v[136:151]
  ds_read_b64_tr_b16 v[28:29], v21 offset:0
  ds_read_b64_tr_b16 v[30:31], v21 offset:256
  v_mfma_f32_32x32x16_bf16 v[152:167], v[44:47], v[200:203], v[152:167]
  ds_read_b64_tr_b16 v[32:33], v20 offset:512
  ds_read_b64_tr_b16 v[34:35], v20 offset:768
  v_mfma_f32_32x32x16_bf16 v[168:183], v[44:47], v[204:207], v[168:183]
  ds_read_b64_tr_b16 v[36:37], v21 offset:512
  ds_read_b64_tr_b16 v[38:39], v21 offset:768
  v_mfma_f32_32x32x16_bf16 v[120:135], v[48:51], v[208:211], v[120:135]
  buffer_load_dwordx4 v[200:203], v4, s[52:55], s12 offen offset:0 sc1
  v_mfma_f32_32x32x16_bf16 v[136:151], v[48:51], v[212:215], v[136:151]
  buffer_load_dwordx4 v[204:207], v5, s[52:55], s12 offen offset:0 sc1
  s_waitcnt lgkmcnt(0)
  s_mov_b32 m0, s28
  s_nop 0
  buffer_load_dwordx4 v2, s[72:75], s30 offen offset:0 lds
  buffer_load_dwordx4 v3, s[72:75], s30 offen offset:1024 lds
  v_mfma_f32_32x32x16_bf16 v[152:167], v[52:55], v[208:211], v[152:167]
  buffer_load_dwordx4 v2, s[72:75], s30 offen offset:2048 lds
  buffer_load_dwordx4 v3, s[72:75], s30 offen offset:3072 lds
  s_add_u32 s30, s30, 32768
  s_cmp_eq_u32 s30, s31
  s_cselect_b32 s30, s81, s30
  v_mfma_f32_32x32x16_bf16 v[168:183], v[52:55], v[212:215], v[168:183]
  buffer_load_dwordx4 v[208:211], v4, s[52:55], s12 offen offset:1024 sc1
  buffer_load_dwordx4 v[212:215], v5, s[52:55], s12 offen offset:1024 sc1
  s_add_u32 s12, s12, 2048
  s_cmp_eq_u32 s12, s15
  s_cselect_b32 s12, s9, s12
  s_waitcnt vmcnt(16)
  v_mfma_f32_32x32x16_bf16 v[120:135], v[56:59], v[216:219], v[120:135]
  ds_read_b64_tr_b16 v[40:41], v6 offset:53248
  ds_read_b64_tr_b16 v[42:43], v6 offset:53504
  v_mfma_f32_32x32x16_bf16 v[136:151], v[56:59], v[220:223], v[136:151]
  ds_read_b64_tr_b16 v[44:45], v7 offset:53248
  ds_read_b64_tr_b16 v[46:47], v7 offset:53504
  v_mfma_f32_32x32x16_bf16 v[152:167], v[60:63], v[216:219], v[152:167]
  ds_read_b64_tr_b16 v[48:49], v6 offset:53760
  ds_read_b64_tr_b16 v[50:51], v6 offset:54016
  v_mfma_f32_32x32x16_bf16 v[168:183], v[60:63], v[220:223], v[168:183]
  ds_read_b64_tr_b16 v[52:53], v7 offset:53760
  ds_read_b64_tr_b16 v[54:55], v7 offset:54016
  v_mfma_f32_32x32x16_bf16 v[120:135], v[64:67], v[224:227], v[120:135]
  buffer_load_dwordx4 v[216:219], v4, s[52:55], s12 offen offset:0 sc1
  v_mfma_f32_32x32x16_bf16 v[136:151], v[64:67], v[228:231], v[136:151]
  buffer_load_dwordx4 v[220:223], v5, s[52:55], s12 offen offset:0 sc1
  s_waitcnt lgkmcnt(0)
  s_mov_b32 m0, s29
  s_nop 0
  buffer_load_dwordx4 v2, s[72:75], s30 offen offset:0 lds
  buffer_load_dwordx4 v3, s[72:75], s30 offen offset:1024 lds
  v_mfma_f32_32x32x16_bf16 v[152:167], v[68:71], v[224:227], v[152:167]
  buffer_load_dwordx4 v2, s[72:75], s30 offen offset:2048 lds
  buffer_load_dwordx4 v3, s[72:75], s30 offen offset:3072 lds
  s_add_u32 s30, s30, 32768
  s_cmp_eq_u32 s30, s31
  s_cselect_b32 s30, s81, s30
  v_mfma_f32_32x32x16_bf16 v[168:183], v[68:71], v[228:231], v[168:183]
  buffer_load_dwordx4 v[224:227], v4, s[52:55], s12 offen offset:1024 sc1
  buffer_load_dwordx4 v[228:231], v5, s[52:55], s12 offen offset:1024 sc1
  s_add_u32 s12, s12, 2048
  s_cmp_eq_u32 s12, s15
  s_cselect_b32 s12, s9, s12
  s_waitcnt vmcnt(20)
  v_mfma_f32_32x32x16_bf16 v[120:135], v[72:75], v[232:235], v[120:135]
  ds_read_b64_tr_b16 v[56:57], v6 offset:49152
  ds_read_b64_tr_b16 v[58:59], v6 offset:49408
  v_mfma_f32_32x32x16_bf16 v[136:151], v[72:75], v[236:239], v[136:151]
  ds_read_b64_tr_b16 v[60:61], v7 offset:49152
  ds_read_b64_tr_b16 v[62:63], v7 offset:49408
  v_mfma_f32_32x32x16_bf16 v[152:167], v[76:79], v[232:235], v[152:167]
  ds_read_b64_tr_b16 v[64:65], v6 offset:49664
  ds_read_b64_tr_b16 v[66:67], v6 offset:49920
  v_mfma_f32_32x32x16_bf16 v[168:183], v[76:79], v[236:239], v[168:183]
  ds_read_b64_tr_b16 v[68:69], v7 offset:49664
  ds_read_b64_tr_b16 v[70:71], v7 offset:49920
  v_mfma_f32_32x32x16_bf16 v[120:135], v[80:83], v[240:243], v[120:135]
  buffer_load_dwordx4 v[232:235], v4, s[52:55], s12 offen offset:0 sc1
  v_mfma_f32_32x32x16_bf16 v[136:151], v[80:83], v[244:247], v[136:151]
  buffer_load_dwordx4 v[236:239], v5, s[52:55], s12 offen offset:0 sc1
  s_waitcnt lgkmcnt(0)
  s_mov_b32 m0, s26
  s_nop 0
  buffer_load_dwordx4 v2, s[72:75], s30 offen offset:0 lds
  buffer_load_dwordx4 v3, s[72:75], s30 offen offset:1024 lds
  v_mfma_f32_32x32x16_bf16 v[152:167], v[84:87], v[240:243], v[152:167]
  buffer_load_dwordx4 v2, s[72:75], s30 offen offset:2048 lds
  buffer_load_dwordx4 v3, s[72:75], s30 offen offset:3072 lds
  s_add_u32 s30, s30, 32768
  s_cmp_eq_u32 s30, s31
  s_cselect_b32 s30, s81, s30
  v_mfma_f32_32x32x16_bf16 v[168:183], v[84:87], v[244:247], v[168:183]
  buffer_load_dwordx4 v[240:243], v4, s[52:55], s12 offen offset:1024 sc1
  buffer_load_dwordx4 v[244:247], v5, s[52:55], s12 offen offset:1024 sc1
  s_add_u32 s12, s12, 2048
  s_cmp_eq_u32 s12, s15
  s_cselect_b32 s12, s9, s12
  s_waitcnt vmcnt(24)
  v_mfma_f32_32x32x16_bf16 v[120:135], v[88:91], v[184:187], v[120:135]
  ds_read_b64_tr_b16 v[72:73], v20 offset:32768
  ds_read_b64_tr_b16 v[74:75], v20 offset:33024
  v_mfma_f32_32x32x16_bf16 v[136:151], v[88:91], v[188:191], v[136:151]
  ds_read_b64_tr_b16 v[76:77], v21 offset:32768
  ds_read_b64_tr_b16 v[78:79], v21 offset:33024
  v_mfma_f32_32x32x16_bf16 v[152:167], v[92:95], v[184:187], v[152:167]
  ds_read_b64_tr_b16 v[80:81], v20 offset:33280
  ds_read_b64_tr_b16 v[82:83], v20 offset:33536
  v_mfma_f32_32x32x16_bf16 v[168:183], v[92:95], v[188:191], v[168:183]
  ds_read_b64_tr_b16 v[84:85], v21 offset:33280
  ds_read_b64_tr_b16 v[86:87], v21 offset:33536
  v_mfma_f32_32x32x16_bf16 v[120:135], v[96:99], v[192:195], v[120:135]
  buffer_load_dwordx4 v[184:187], v4, s[52:55], s12 offen offset:0 sc1
  v_mfma_f32_32x32x16_bf16 v[136:151], v[96:99], v[196:199], v[136:151]
  buffer_load_dwordx4 v[188:191], v5, s[52:55], s12 offen offset:0 sc1
  s_waitcnt lgkmcnt(0)
  s_mov_b32 m0, s27
  s_nop 0
  buffer_load_dwordx4 v2, s[72:75], s30 offen offset:0 lds
  buffer_load_dwordx4 v3, s[72:75], s30 offen offset:1024 lds
  v_mfma_f32_32x32x16_bf16 v[152:167], v[100:103], v[192:195], v[152:167]
  buffer_load_dwordx4 v2, s[72:75], s30 offen offset:2048 lds
  buffer_load_dwordx4 v3, s[72:75], s30 offen offset:3072 lds
  s_add_u32 s30, s30, 32768
  s_cmp_eq_u32 s30, s31
  s_cselect_b32 s30, s81, s30
  v_mfma_f32_32x32x16_bf16 v[168:183], v[100:103], v[196:199], v[168:183]
  buffer_load_dwordx4 v[192:195], v4, s[52:55], s12 offen offset:1024 sc1
  buffer_load_dwordx4 v[196:199], v5, s[52:55], s12 offen offset:1024 sc1
  s_add_u32 s12, s12, 2048
  s_cmp_eq_u32 s12, s15
  s_cselect_b32 s12, s9, s12
  s_waitcnt vmcnt(24)
  v_mfma_f32_32x32x16_bf16 v[120:135], v[104:107], v[200:203], v[120:135]
  ds_read_b64_tr_b16 v[88:89], v20 offset:0
  ds_read_b64_tr_b16 v[90:91], v20 offset:256
  v_mfma_f32_32x32x16_bf16 v[136:151], v[104:107], v[204:207], v[136:151]
  ds_read_b64_tr_b16 v[92:93], v21 offset:0
  ds_read_b64_tr_b16 v[94:95], v21 offset:256
  v_mfma_f32_32x32x16_bf16 v[152:167], v[108:111], v[200:203], v[152:167]
  ds_read_b64_tr_b16 v[96:97], v20 offset:512
  ds_read_b64_tr_b16 v[98:99], v20 offset:768
  v_mfma_f32_32x32x16_bf16 v[168:183], v[108:111], v[204:207], v[168:183]
  ds_read_b64_tr_b16 v[100:101], v21 offset:512
  ds_read_b64_tr_b16 v[102:103], v21 offset:768
  v_mfma_f32_32x32x16_bf16 v[120:135], v[112:115], v[208:211], v[120:135]
  buffer_load_dwordx4 v[200:203], v4, s[52:55], s12 offen offset:0 sc1
  v_mfma_f32_32x32x16_bf16 v[136:151], v[112:115], v[212:215], v[136:151]
  buffer_load_dwordx4 v[204:207], v5, s[52:55], s12 offen offset:0 sc1
  v_mfma_f32_32x32x16_bf16 v[152:167], v[116:119], v[208:211], v[152:167]
  v_mfma_f32_32x32x16_bf16 v[168:183], v[116:119], v[212:215], v[168:183]
  buffer_load_dwordx4 v[208:211], v4, s[52:55], s12 offen offset:1024 sc1
  buffer_load_dwordx4 v[212:215], v5, s[52:55], s12 offen offset:1024 sc1
  s_add_u32 s12, s12, 2048
  s_cmp_eq_u32 s12, s15
  s_cselect_b32 s12, s9, s12
  v_and_b32 v10, 31, v1
  v_lshlrev_b32 v10, 7, v10
  s_lshl_b32 s43, s4, 12
  s_add_u32 s43, s43, 32768
  buffer_load_dword v11, v10, s[76:79], s43 offen sc1
  s_waitcnt vmcnt(21)
  v_mfma_f32_32x32x16_bf16 v[120:135], v[24:27], v[216:219], v[120:135]
  ds_read_b64_tr_b16 v[104:105], v6 offset:53248
  ds_read_b64_tr_b16 v[106:107], v6 offset:53504
  v_mfma_f32_32x32x16_bf16 v[136:151], v[24:27], v[220:223], v[136:151]
  ds_read_b64_tr_b16 v[108:109], v7 offset:53248
  ds_read_b64_tr_b16 v[110:111], v7 offset:53504
  v_mfma_f32_32x32x16_bf16 v[152:167], v[28:31], v[216:219], v[152:167]
  ds_read_b64_tr_b16 v[112:113], v6 offset:53760
  ds_read_b64_tr_b16 v[114:115], v6 offset:54016
  v_mfma_f32_32x32x16_bf16 v[168:183], v[28:31], v[220:223], v[168:183]
  ds_read_b64_tr_b16 v[116:117], v7 offset:53760
  ds_read_b64_tr_b16 v[118:119], v7 offset:54016
  v_mfma_f32_32x32x16_bf16 v[120:135], v[32:35], v[224:227], v[120:135]
  buffer_load_dwordx4 v[216:219], v4, s[52:55], s12 offen offset:0 sc1
  v_mfma_f32_32x32x16_bf16 v[136:151], v[32:35], v[228:231], v[136:151]
  buffer_load_dwordx4 v[220:223], v5, s[52:55], s12 offen offset:0 sc1
  v_mfma_f32_32x32x16_bf16 v[152:167], v[36:39], v[224:227], v[152:167]
  v_mfma_f32_32x32x16_bf16 v[168:183], v[36:39], v[228:231], v[168:183]
  buffer_load_dwordx4 v[224:227], v4, s[52:55], s12 offen offset:1024 sc1
  buffer_load_dwordx4 v[228:231], v5, s[52:55], s12 offen offset:1024 sc1
  s_add_u32 s12, s12, 2048
  s_cmp_eq_u32 s12, s15
  s_cselect_b32 s12, s9, s12
  s_waitcnt vmcnt(17)
  v_mfma_f32_32x32x16_bf16 v[120:135], v[40:43], v[232:235], v[120:135]
  ds_read_b64_tr_b16 v[24:25], v6 offset:49152
  ds_read_b64_tr_b16 v[26:27], v6 offset:49408
  v_mfma_f32_32x32x16_bf16 v[136:151], v[40:43], v[236:239], v[136:151]
  ds_read_b64_tr_b16 v[28:29], v7 offset:49152
  ds_read_b64_tr_b16 v[30:31], v7 offset:49408
  v_mfma_f32_32x32x16_bf16 v[152:167], v[44:47], v[232:235], v[152:167]
  ds_read_b64_tr_b16 v[32:33], v6 offset:49664
  ds_read_b64_tr_b16 v[34:35], v6 offset:49920
  v_mfma_f32_32x32x16_bf16 v[168:183], v[44:47], v[236:239], v[168:183]
  ds_read_b64_tr_b16 v[36:37], v7 offset:49664
  ds_read_b64_tr_b16 v[38:39], v7 offset:49920
  v_mfma_f32_32x32x16_bf16 v[120:135], v[48:51], v[240:243], v[120:135]
  buffer_load_dwordx4 v[232:235], v4, s[52:55], s12 offen offset:0 sc1
  v_mfma_f32_32x32x16_bf16 v[136:151], v[48:51], v[244:247], v[136:151]
  buffer_load_dwordx4 v[236:239], v5, s[52:55], s12 offen offset:0 sc1
  v_mfma_f32_32x32x16_bf16 v[152:167], v[52:55], v[240:243], v[152:167]
  v_mfma_f32_32x32x16_bf16 v[168:183], v[52:55], v[244:247], v[168:183]
  buffer_load_dwordx4 v[240:243], v4, s[52:55], s12 offen offset:1024 sc1
  buffer_load_dwordx4 v[244:247], v5, s[52:55], s12 offen offset:1024 sc1
  s_add_u32 s12, s12, 2048
  s_cmp_eq_u32 s12, s15
  s_cselect_b32 s12, s9, s12
  s_mov_b32 s6, 0
  s_waitcnt vmcnt(8)
  s_cmp_lg_u32 s7, 0
  s_cbranch_scc1 Lpld_11
  v_cmp_ne_u32 vcc, s82, v11
  s_cbranch_vccz Lpld_11
Lpl_10:
  buffer_load_dword v11, v10, s[76:79], s43 offen sc1
  s_add_u32 s6, s6, 1
  s_waitcnt vmcnt(0)
  v_cmp_ne_u32 vcc, s82, v11
  s_cbranch_vccz Lpld_11
  s_cmp_gt_u32 s6, 65536
  s_cbranch_scc1 Lpld_11
  s_sleep 8
  s_branch Lpl_10
Lpld_11:
  s_barrier
  s_lshl_b32 s43, s5, 16
  s_lshl_b32 s6, s4, 13
  s_add_u32 s43, s43, s6
  s_lshl_b32 s6, s7, 11
  s_add_u32 s43, s43, s6
  buffer_load_dwordx4 v[248:251], v4, s[60:63], s43 offen offset:0 sc1
  buffer_load_dwordx4 v[252:255], v4, s[60:63], s43 offen offset:1024 sc1
  buffer_load_dword v9, v22, s[64:67], s42 offen sc1
  v_lshrrev_b32 v10, 3, v1
  v_mul_u32_u24 v10, 144, v10
  v_and_b32 v11, 7, v1
  v_lshl_add_u32 v11, v11, 4, v10
  s_mul_i32 s6, s7, 2304
  s_add_u32 s6, s6, 16384
  v_add_u32 v11, s6, v11
  v_lshrrev_b32 v23, 4, v1
  v_bfe_u32 v10, v1, 2, 2
  v_lshl_add_u32 v23, v23, 3, v10
  v_mul_u32_u24 v23, 144, v23
  v_and_b32 v10, 3, v1
  v_lshl_add_u32 v23, v10, 3, v23
  s_lshl_b32 s6, s7, 5
  s_add_u32 s6, s6, 16384
  v_add_u32 v23, s6, v23
  v_mfma_f32_32x32x16_bf16 v[120:135], v[56:59], v[184:187], v[120:135]
  ds_read_b64_tr_b16 v[40:41], v20 offset:32768
  ds_read_b64_tr_b16 v[42:43], v20 offset:33024
  v_mfma_f32_32x32x16_bf16 v[136:151], v[56:59], v[188:191], v[136:151]
  ds_read_b64_tr_b16 v[44:45], v21 offset:32768
  ds_read_b64_tr_b16 v[46:47], v21 offset:33024
  v_mfma_f32_32x32x16_bf16 v[152:167], v[60:63], v[184:187], v[152:167]
  ds_read_b64_tr_b16 v[48:49], v20 offset:33280
  ds_read_b64_tr_b16 v[50:51], v20 offset:33536
  v_mfma_f32_32x32x16_bf16 v[168:183], v[60:63], v[188:191], v[168:183]
  ds_read_b64_tr_b16 v[52:53], v21 offset:33280
  ds_read_b64_tr_b16 v[54:55], v21 offset:33536
  v_mfma_f32_32x32x16_bf16 v[120:135], v[64:67], v[192:195], v[120:135]
  buffer_load_dwordx4 v[184:187], v4, s[52:55], s12 offen offset:0 sc1
  v_mfma_f32_32x32x16_bf16 v[136:151], v[64:67], v[196:199], v[136:151]
  buffer_load_dwordx4 v[188:191], v5, s[52:55], s12 offen offset:0 sc1
  v_mfma_f32_32x32x16_bf16 v[152:167], v[68:71], v[192:195], v[152:167]
  v_mfma_f32_32x32x16_bf16 v[168:183], v[68:71], v[196:199], v[168:183]
  buffer_load_dwordx4 v[192:195], v4, s[52:55], s12 offen offset:1024 sc1
  buffer_load_dwordx4 v[196:199], v5, s[52:55], s12 offen offset:1024 sc1
  s_add_u32 s12, s12, 2048
  s_cmp_eq_u32 s12, s15
  s_cselect_b32 s12, s9, s12
  v_mfma_f32_32x32x16_bf16 v[120:135], v[72:75], v[200:203], v[120:135]
  v_mfma_f32_32x32x16_bf16 v[136:151], v[72:75], v[204:207], v[136:151]
  v_mfma_f32_32x32x16_bf16 v[152:167], v[76:79], v[200:203], v[152:167]
  v_mfma_f32_32x32x16_bf16 v[168:183], v[76:79], v[204:207], v[168:183]
  v_mfma_f32_32x32x16_bf16 v[120:135], v[80:83], v[208:211], v[120:135]
  buffer_load_dwordx4 v[200:203], v4, s[52:55], s12 offen offset:0 sc1
  v_mfma_f32_32x32x16_bf16 v[136:151], v[80:83], v[212:215], v[136:151]
  buffer_load_dwordx4 v[204:207], v5, s[52:55], s12 offen offset:0 sc1
  v_mfma_f32_32x32x16_bf16 v[152:167], v[84:87], v[208:211], v[152:167]
  v_mfma_f32_32x32x16_bf16 v[168:183], v[84:87], v[212:215], v[168:183]
  buffer_load_dwordx4 v[208:211], v4, s[52:55], s12 offen offset:1024 sc1
  buffer_load_dwordx4 v[212:215], v5, s[52:55], s12 offen offset:1024 sc1
  s_add_u32 s12, s12, 2048
  s_cmp_eq_u32 s12, s15
  s_cselect_b32 s12, s9, s12
  s_waitcnt vmcnt(9)
  ds_write_b128 v11, v[248:251] offset:0
  ds_write_b128 v11, v[252:255] offset:1152
  s_waitcnt lgkmcnt(0)
  s_barrier
  ds_read_b64_tr_b16 v[248:249], v23 offset:0
  ds_read_b64_tr_b16 v[250:251], v23 offset:576
  ds_read_b64_tr_b16 v[252:253], v23 offset:4608
  ds_read_b64_tr_b16 v[254:255], v23 offset:5184
  v_mfma_f32_32x32x16_bf16 v[120:135], v[88:91], v[216:219], v[120:135]
  v_mfma_f32_32x32x16_bf16 v[136:151], v[88:91], v[220:223], v[136:151]
  v_mfma_f32_32x32x16_bf16 v[152:167], v[92:95], v[216:219], v[152:167]
  v_mfma_f32_32x32x16_bf16 v[168:183], v[92:95], v[220:223], v[168:183]
  v_mfma_f32_32x32x16_bf16 v[120:135], v[96:99], v[224:227], v[120:135]
  v_mfma_f32_32x32x16_bf16 v[136:151], v[96:99], v[228:231], v[136:151]
  v_mfma_f32_32x32x16_bf16 v[152:167], v[100:103], v[224:227], v[152:167]
  v_mfma_f32_32x32x16_bf16 v[168:183], v[100:103], v[228:231], v[168:183]
  s_waitcnt lgkmcnt(0)
  s_barrier
  s_mov_b32 s81, 0xffff0000
  v_mfma_f32_32x32x16_bf16 v[120:135], v[104:107], v[232:235], v[120:135]
  v_lshlrev_b32 v72, 16, v12
  v_and_b32 v73, s81, v12
  v_lshlrev_b32 v10, 16, v248
  v_and_b32 v23, s81, v248
  v_add_f32 v72, v72, v10
  v_mfma_f32_32x32x16_bf16 v[136:151], v[104:107], v[236:239], v[136:151]
  v_add_f32 v73, v73, v23
  v_cvt_pk_bf16_f32 v12, v72, v73
  v_lshlrev_b32 v72, 16, v12
  v_and_b32 v73, s81, v12
  v_lshlrev_b32 v74, 16, v13
  v_mfma_f32_32x32x16_bf16 v[152:167], v[108:111], v[232:235], v[152:167]
  v_and_b32 v75, s81, v13
  v_lshlrev_b32 v10, 16, v249
  v_and_b32 v23, s81, v249
  v_add_f32 v74, v74, v10
  v_add_f32 v75, v75, v23
  v_mfma_f32_32x32x16_bf16 v[168:183], v[108:111], v[236:239], v[168:183]
  v_cvt_pk_bf16_f32 v13, v74, v75
  v_lshlrev_b32 v74, 16, v13
  v_and_b32 v75, s81, v13
  v_lshlrev_b32 v76, 16, v14
  v_and_b32 v77, s81, v14
  v_mfma_f32_32x32x16_bf16 v[120:135], v[112:115], v[240:243], v[120:135]
  v_lshlrev_b32 v10, 16, v250
  v_and_b32 v23, s81, v250
  v_add_f32 v76, v76, v10
  v_add_f32 v77, v77, v23
  v_cvt_pk_bf16_f32 v14, v76, v77
  v_mfma_f32_32x32x16_bf16 v[136:151], v[112:115], v[244:247], v[136:151]
  v_lshlrev_b32 v76, 16, v14
  v_and_b32 v77, s81, v14
  v_lshlrev_b32 v78, 16, v15
  v_and_b32 v79, s81, v15
  v_lshlrev_b32 v10, 16, v251
  v_mfma_f32_32x32x16_bf16 v[152:167], v[116:119], v[240:243], v[152:167]
  v_and_b32 v23, s81, v251
  v_add_f32 v78, v78, v10
  v_add_f32 v79, v79, v23
  v_cvt_pk_bf16_f32 v15, v78, v79
  v_lshlrev_b32 v78, 16, v15
  v_mfma_f32_32x32x16_bf16 v[168:183], v[116:119], v[244:247], v[168:183]
  v_and_b32 v79, s81, v15
  v_lshlrev_b32 v80, 16, v16
  v_and_b32 v81, s81, v16
  v_lshlrev_b32 v10, 16, v252
  v_and_b32 v23, s81, v252
  s_waitcnt vmcnt(4)
  v_mfma_f32_32x32x16_bf16 v[120:135], v[24:27], v[184:187], v[120:135]
  v_add_f32 v80, v80, v10
  v_add_f32 v81, v81, v23
  v_cvt_pk_bf16_f32 v16, v80, v81
  v_lshlrev_b32 v80, 16, v16
  v_and_b32 v81, s81, v16
  v_mfma_f32_32x32x16_bf16 v[136:151], v[24:27], v[188:191], v[136:151]
  v_lshlrev_b32 v82, 16, v17
  v_and_b32 v83, s81, v17
  v_lshlrev_b32 v10, 16, v253
  v_and_b32 v23, s81, v253
  v_add_f32 v82, v82, v10
  v_mfma_f32_32x32x16_bf16 v[152:167], v[28:31], v[184:187], v[152:167]
  v_add_f32 v83, v83, v23
  v_cvt_pk_bf16_f32 v17, v82, v83
  v_lshlrev_b32 v82, 16, v17
  v_and_b32 v83, s81, v17
  v_lshlrev_b32 v84, 16, v18
  v_mfma_f32_32x32x16_bf16 v[168:183], v[28:31], v[188:191], v[168:183]
  v_and_b32 v85, s81, v18
  v_lshlrev_b32 v10, 16, v254
  v_and_b32 v23, s81, v254
  v_add_f32 v84, v84, v10
  v_add_f32 v85, v85, v23
  v_mfma_f32_32x32x16_bf16 v[120:135], v[32:35], v[192:195], v[120:135]
  v_cvt_pk_bf16_f32 v18, v84, v85
  v_lshlrev_b32 v84, 16, v18
  v_and_b32 v85, s81, v18
  v_lshlrev_b32 v86, 16, v19
  v_and_b32 v87, s81, v19
  v_mfma_f32_32x32x16_bf16 v[136:151], v[32:35], v[196:199], v[136:151]
  v_lshlrev_b32 v10, 16, v255
  v_and_b32 v23, s81, v255
  v_add_f32 v86, v86, v10
  v_add_f32 v87, v87, v23
  v_cvt_pk_bf16_f32 v19, v86, v87
  v_mfma_f32_32x32x16_bf16 v[152:167], v[36:39], v[192:195], v[152:167]
  v_lshlrev_b32 v86, 16, v19
  v_and_b32 v87, s81, v19
  v_mfma_f32_32x32x16_bf16 v[168:183], v[36:39], v[196:199], v[168:183]
  v_and_b32 v2, 31, v1
  v_mul_u32_u24 v2, 272, v2
  v_lshrrev_b32 v11, 5, v1
  v_lshl_add_u32 v2, v11, 4, v2
  v_add_u32 v2, s10, v2
  s_waitcnt vmcnt(0)
  v_mfma_f32_32x32x16_bf16 v[120:135], v[40:43], v[200:203], v[120:135]
  v_mfma_f32_32x32x16_bf16 v[120:135], v[48:51], v[208:211], v[120:135]
  v_mfma_f32_32x32x16_bf16 v[152:167], v[44:47], v[200:203], v[152:167]
  v_mfma_f32_32x32x16_bf16 v[152:167], v[52:55], v[208:211], v[152:167]
  s_nop 9
  ds_write_b128 v2, v[120:123] offset:0
  ds_write_b128 v2, v[124:127] offset:32
  ds_write_b128 v2, v[128:131] offset:64
  ds_write_b128 v2, v[132:135] offset:96
  v_mfma_f32_32x32x16_bf16 v[136:151], v[40:43], v[204:207], v[136:151]
  v_mfma_f32_32x32x16_bf16 v[136:151], v[48:51], v[212:215], v[136:151]
  ds_write_b128 v2, v[152:155] offset:128
  ds_write_b128 v2, v[156:159] offset:160
  ds_write_b128 v2, v[160:163] offset:192
  ds_write_b128 v2, v[164:167] offset:224
  v_mfma_f32_32x32x16_bf16 v[168:183], v[44:47], v[204:207], v[168:183]
  v_mfma_f32_32x32x16_bf16 v[168:183], v[52:55], v[212:215], v[168:183]
  s_nop 5
  ds_write_b128 v2, v[136:139] offset:8704
  ds_write_b128 v2, v[140:143] offset:8736
  ds_write_b128 v2, v[144:147] offset:8768
  ds_write_b128 v2, v[148:151] offset:8800
  s_nop 1
  ds_write_b128 v2, v[168:171] offset:8832
  ds_write_b128 v2, v[172:175] offset:8864
  ds_write_b128 v2, v[176:179] offset:8896
  ds_write_b128 v2, v[180:183] offset:8928
  v_and_b32 v10, 15, v1
  v_mul_u32_u24 v10, 272, v10
  v_lshrrev_b32 v11, 4, v1
  v_lshl_add_u32 v10, v11, 5, v10
  s_mul_i32 s11, s7, 4352
  v_add_u32 v10, s11, v10
  s_waitcnt lgkmcnt(0)
  s_barrier
  ds_read_b128 v[120:123], v10 offset:0
  ds_read_b128 v[124:127], v10 offset:16
  ds_read_b128 v[128:131], v10 offset:17408
  ds_read_b128 v[132:135], v10 offset:17424
  ds_read_b128 v[136:139], v10 offset:34816
  ds_read_b128 v[140:143], v10 offset:34832
  ds_read_b128 v[144:147], v10 offset:52224
  ds_read_b128 v[148:151], v10 offset:52240
  ds_read_b128 v[152:155], v10 offset:128
  ds_read_b128 v[156:159], v10 offset:144
  ds_read_b128 v[160:163], v10 offset:17536
  ds_read_b128 v[164:167], v10 offset:17552
  ds_read_b128 v[168:171], v10 offset:34944
  ds_read_b128 v[172:175], v10 offset:34960
  ds_read_b128 v[176:179], v10 offset:52352
  ds_read_b128 v[180:183], v10 offset:52368
  s_waitcnt lgkmcnt(12)
  v_pk_add_f32 v[120:121], v[120:121], v[128:129]
  v_pk_add_f32 v[122:123], v[122:123], v[130:131]
  v_pk_add_f32 v[124:125], v[124:125], v[132:133]
  v_pk_add_f32 v[126:127], v[126:127], v[134:135]
  s_waitcnt lgkmcnt(8)
  v_pk_add_f32 v[136:137], v[136:137], v[144:145]
  v_pk_add_f32 v[138:139], v[138:139], v[146:147]
  v_pk_add_f32 v[140:141], v[140:141], v[148:149]
  v_pk_add_f32 v[142:143], v[142:143], v[150:151]
  v_pk_add_f32 v[120:121], v[120:121], v[136:137]
  v_pk_add_f32 v[122:123], v[122:123], v[138:139]
  v_pk_add_f32 v[124:125], v[124:125], v[140:141]
  v_pk_add_f32 v[126:127], v[126:127], v[142:143]
  v_pk_mul_f32 v[120:121], v[120:121], v[8:9] op_sel:[0,1]
  v_pk_mul_f32 v[122:123], v[122:123], v[8:9] op_sel:[0,1]
  v_pk_mul_f32 v[124:125], v[124:125], v[8:9] op_sel:[0,1]
  v_pk_mul_f32 v[126:127], v[126:127], v[8:9] op_sel:[0,1]
  v_cvt_pk_bf16_f32 v128, v120, v121
  v_cvt_pk_bf16_f32 v129, v122, v123
  v_cvt_pk_bf16_f32 v130, v124, v125
  v_cvt_pk_bf16_f32 v131, v126, v127
  v_lshlrev_b32 v120, 16, v128
  v_and_b32 v121, s81, v128
  v_lshlrev_b32 v122, 16, v129
  v_and_b32 v123, s81, v129
  v_lshlrev_b32 v124, 16, v130
  v_and_b32 v125, s81, v130
  v_lshlrev_b32 v126, 16, v131
  v_and_b32 v127, s81, v131
  v_pk_add_f32 v[120:121], v[120:121], v[72:73]
  v_pk_add_f32 v[122:123], v[122:123], v[74:75]
  v_pk_add_f32 v[124:125], v[124:125], v[76:77]
  v_pk_add_f32 v[126:127], v[126:127], v[78:79]
  v_cvt_pk_bf16_f32 v128, v120, v121
  v_cvt_pk_bf16_f32 v129, v122, v123
  v_cvt_pk_bf16_f32 v130, v124, v125
  v_cvt_pk_bf16_f32 v131, v126, v127
  buffer_store_dwordx4 v[128:131], v8, s[56:59], s13 offen offset:0
  s_waitcnt lgkmcnt(4)
  v_pk_add_f32 v[152:153], v[152:153], v[160:161]
  v_pk_add_f32 v[154:155], v[154:155], v[162:163]
  v_pk_add_f32 v[156:157], v[156:157], v[164:165]
  v_pk_add_f32 v[158:159], v[158:159], v[166:167]
  s_waitcnt lgkmcnt(0)
  v_pk_add_f32 v[168:169], v[168:169], v[176:177]
  v_pk_add_f32 v[170:171], v[170:171], v[178:179]
  v_pk_add_f32 v[172:173], v[172:173], v[180:181]
  v_pk_add_f32 v[174:175], v[174:175], v[182:183]
  v_pk_add_f32 v[152:153], v[152:153], v[168:169]
  v_pk_add_f32 v[154:155], v[154:155], v[170:171]
  v_pk_add_f32 v[156:157], v[156:157], v[172:173]
  v_pk_add_f32 v[158:159], v[158:159], v[174:175]
  v_pk_mul_f32 v[152:153], v[152:153], v[8:9] op_sel:[0,1]
  v_pk_mul_f32 v[154:155], v[154:155], v[8:9] op_sel:[0,1]
  v_pk_mul_f32 v[156:157], v[156:157], v[8:9] op_sel:[0,1]
  v_pk_mul_f32 v[158:159], v[158:159], v[8:9] op_sel:[0,1]
  v_cvt_pk_bf16_f32 v160, v152, v153
  v_cvt_pk_bf16_f32 v161, v154, v155
  v_cvt_pk_bf16_f32 v162, v156, v157
  v_cvt_pk_bf16_f32 v163, v158, v159
  v_lshlrev_b32 v152, 16, v160
  v_and_b32 v153, s81, v160
  v_lshlrev_b32 v154, 16, v161
  v_and_b32 v155, s81, v161
  v_lshlrev_b32 v156, 16, v162
  v_and_b32 v157, s81, v162
  v_lshlrev_b32 v158, 16, v163
  v_and_b32 v159, s81, v163
  v_pk_add_f32 v[152:153], v[152:153], v[80:81]
  v_pk_add_f32 v[154:155], v[154:155], v[82:83]
  v_pk_add_f32 v[156:157], v[156:157], v[84:85]
  v_pk_add_f32 v[158:159], v[158:159], v[86:87]
  v_cvt_pk_bf16_f32 v160, v152, v153
  v_cvt_pk_bf16_f32 v161, v154, v155
  v_cvt_pk_bf16_f32 v162, v156, v157
  v_cvt_pk_bf16_f32 v163, v158, v159
  buffer_store_dwordx4 v[160:163], v8, s[56:59], s13 offen offset:64
  s_endpgm
Lside:
  s_setprio 3
  s_lshl_b32 s5, s3, 5
  s_add_u32 s5, s5, s4
  s_lshl_b32 s6, s5, 1
  s_lshr_b32 s42, s7, 1
  s_add_u32 s8, s42, s6
  s_and_b32 s43, s7, 1
  s_lshl_b32 s9, s5, 3
  s_lshl_b32 s10, s7, 1
  s_add_u32 s9, s9, s10
  s_lshl_b32 s10, s9, 10
  v_lshlrev_b32 v2, 4, v1
  s_lshl_b32 s11, s43, 7
  s_lshl_b32 s12, s8, 8
  s_add_u32 s11, s11, s12
  v_lshlrev_b32 v3, 1, v1
  s_lshl_b32 s12, s6, 1
  s_waitcnt lgkmcnt(0)
  s_mov_b32 s44, s16
  s_and_b32 s45, s17, 0xffff
  s_mov_b32 s46, 2097152
  s_mov_b32 s47, 0x20000
  buffer_load_dwordx4 v[8:11], v2, s[44:47], s10 offen
  buffer_load_dwordx4 v[12:15], v2, s[44:47], s10 offen offset:1024
  s_load_dword s72, s[26:27], s12
  s_load_dword s70, s[28:29], s12
  s_mov_b32 s60, s18
  s_and_b32 s61, s19, 0xffff
  s_mov_b32 s62, 131072
  s_mov_b32 s63, 0x20000
  buffer_load_ushort v4, v3, s[60:63], s11 offen
  s_mov_b32 s60, s20
  s_and_b32 s61, s21, 0xffff
  s_mov_b32 s62, 131072
  s_mov_b32 s63, 0x20000
  buffer_load_ushort v5, v3, s[60:63], s11 offen
  s_mov_b32 s60, s22
  s_and_b32 s61, s23, 0xffff
  s_mov_b32 s62, 131072
  s_mov_b32 s63, 0x20000
  buffer_load_ushort v6, v3, s[60:63], s11 offen
  s_mov_b32 s60, s24
  s_and_b32 s61, s25, 0xffff
  s_mov_b32 s62, 131072
  s_mov_b32 s63, 0x20000
  buffer_load_ushort v7, v3, s[60:63], s11 offen
  s_cmp_lg_u32 s7, 3
  s_cbranch_scc1 Lmw_12
  s_cmp_eq_u32 s7, 2
  s_cselect_b32 s60, s32, s34
  s_cselect_b32 s61, s33, s35
  s_and_b32 s61, s61, 0xffff
  s_mov_b32 s62, 1835008
  s_mov_b32 s63, 0x20000
  s_mul_i32 s13, s5, 7168
  v_min_u32 v78, 55, v1
  v_lshlrev_b32 v78, 7, v78
  buffer_load_dword v79, v78, s[60:63], s13 offen
Lmw_12:
  s_add_u32 s48, s40, 8388608
  s_addc_u32 s49, s41, 0
  s_and_b32 s49, s49, 0xffff
  s_mov_b32 s50, 2097152
  s_mov_b32 s51, 0x20000
  s_add_u32 s52, s40, 12582912
  s_addc_u32 s53, s41, 0
  s_and_b32 s53, s53, 0xffff
  s_mov_b32 s54, 8192
  s_mov_b32 s55, 0x20000
  s_add_u32 s56, s40, 10485760
  s_addc_u32 s57, s41, 0
  s_and_b32 s57, s57, 0xffff
  s_mov_b32 s58, 2097152
  s_mov_b32 s59, 0x20000
  s_add_u32 s76, s40, 12648448
  s_addc_u32 s77, s41, 0
  s_and_b32 s77, s77, 0xffff
  s_mov_b32 s78, 131072
  s_mov_b32 s79, 0x20000
  v_mov_b32 v16, 0x3f803f80
  v_mov_b32 v18, 0
  v_mov_b32 v19, 0
  s_mov_b32 s80, 0x3fb8aa3b
  s_mov_b32 s81, 0xffff0000
  v_bfe_u32 v44, v1, 2, 2
  v_sub_u32 v44, 3, v44
  v_mul_u32_u24 v44, 1088, v44
  v_lshrrev_b32 v21, 4, v1
  v_lshl_add_u32 v44, v21, 5, v44
  v_and_b32 v21, 3, v1
  v_lshl_add_u32 v44, v21, 3, v44
  s_lshl_b32 s13, s7, 8
  s_add_u32 s13, s13, 65664
  v_add_u32 v44, s13, v44
  s_mul_i32 s13, s7, 2176
  s_add_u32 s13, s13, 65664
  v_add_u32 v45, s13, v2
  s_waitcnt vmcnt(4)
  v_lshlrev_b32 v24, 16, v8
  v_and_b32 v25, s81, v8
  v_lshlrev_b32 v26, 16, v9
  v_and_b32 v27, s81, v9
  v_lshlrev_b32 v28, 16, v10
  v_and_b32 v29, s81, v10
  v_lshlrev_b32 v30, 16, v11
  v_and_b32 v31, s81, v11
  v_lshlrev_b32 v32, 16, v12
  v_and_b32 v33, s81, v12
  v_lshlrev_b32 v34, 16, v13
  v_and_b32 v35, s81, v13
  v_lshlrev_b32 v36, 16, v14
  v_and_b32 v37, s81, v14
  v_lshlrev_b32 v38, 16, v15
  v_and_b32 v39, s81, v15
  v_add_f32 v18, v24, v25
  v_add_f32 v20, v26, v27
  v_add_f32 v22, v28, v29
  v_add_f32 v40, v30, v31
  v_add_f32 v19, v32, v33
  v_add_f32 v21, v34, v35
  v_add_f32 v23, v36, v37
  v_add_f32 v41, v38, v39
  v_add_f32 v18, v18, v20
  v_add_f32 v22, v22, v40
  v_add_f32 v19, v19, v21
  v_add_f32 v23, v23, v41
  v_add_f32 v18, v18, v22
  v_add_f32 v19, v19, v23
  s_nop 0
  v_add_f32_dpp v18, v18, v18 row_shr:1 row_mask:0xf bank_mask:0xf
  v_add_f32_dpp v19, v19, v19 row_shr:1 row_mask:0xf bank_mask:0xf
  s_nop 0
  v_add_f32_dpp v18, v18, v18 row_shr:2 row_mask:0xf bank_mask:0xf
  v_add_f32_dpp v19, v19, v19 row_shr:2 row_mask:0xf bank_mask:0xf
  s_nop 0
  v_add_f32_dpp v18, v18, v18 row_shr:4 row_mask:0xf bank_mask:0xf
  v_add_f32_dpp v19, v19, v19 row_shr:4 row_mask:0xf bank_mask:0xf
  s_nop 0
  v_add_f32_dpp v18, v18, v18 row_shr:8 row_mask:0xf bank_mask:0xf
  v_add_f32_dpp v19, v19, v19 row_shr:8 row_mask:0xf bank_mask:0xf
  s_nop 0
  v_add_f32_dpp v18, v18, v18 row_bcast:15 row_mask:0xa bank_mask:0xf
  v_add_f32_dpp v19, v19, v19 row_bcast:15 row_mask:0xa bank_mask:0xf
  s_nop 0
  v_add_f32_dpp v18, v18, v18 row_bcast:31 row_mask:0xc bank_mask:0xf
  v_add_f32_dpp v19, v19, v19 row_bcast:31 row_mask:0xc bank_mask:0xf
  v_mul_f32 v18, 0x3b000000, v18
  v_mul_f32 v19, 0x3b000000, v19
  v_cvt_pk_bf16_f32 v20, v18, v19
  v_lshlrev_b32 v21, 16, v20
  v_and_b32 v20, s81, v20
  v_sub_f32 v18, v18, v21
  v_sub_f32 v19, v19, v20
  v_readlane_b32 s74, v21, 63
  v_readlane_b32 s14, v20, 63
  s_nop 0
  v_subrev_f32 v24, s74, v24
  v_subrev_f32 v32, s14, v32
  v_subrev_f32 v25, s74, v25
  v_subrev_f32 v33, s14, v33
  v_subrev_f32 v26, s74, v26
  v_subrev_f32 v34, s14, v34
  v_subrev_f32 v27, s74, v27
  v_subrev_f32 v35, s14, v35
  v_subrev_f32 v28, s74, v28
  v_subrev_f32 v36, s14, v36
  v_subrev_f32 v29, s74, v29
  v_subrev_f32 v37, s14, v37
  v_subrev_f32 v30, s74, v30
  v_subrev_f32 v38, s14, v38
  v_subrev_f32 v31, s74, v31
  v_subrev_f32 v39, s14, v39
  v_mul_f32 v40, v24, v24
  v_mul_f32 v42, v32, v32
  v_mul_f32 v41, v25, v25
  v_mul_f32 v43, v33, v33
  v_fmac_f32 v40, v26, v26
  v_fmac_f32 v42, v34, v34
  v_fmac_f32 v41, v27, v27
  v_fmac_f32 v43, v35, v35
  v_fmac_f32 v40, v28, v28
  v_fmac_f32 v42, v36, v36
  v_fmac_f32 v41, v29, v29
  v_fmac_f32 v43, v37, v37
  v_fmac_f32 v40, v30, v30
  v_fmac_f32 v42, v38, v38
  v_fmac_f32 v41, v31, v31
  v_fmac_f32 v43, v39, v39
  v_add_f32 v40, v40, v41
  v_add_f32 v42, v42, v43
  v_cvt_pk_bf16_f32 v8, v24, v25
  v_cvt_pk_bf16_f32 v9, v26, v27
  v_cvt_pk_bf16_f32 v10, v28, v29
  v_cvt_pk_bf16_f32 v11, v30, v31
  v_cvt_pk_bf16_f32 v12, v32, v33
  v_cvt_pk_bf16_f32 v13, v34, v35
  v_cvt_pk_bf16_f32 v14, v36, v37
  v_cvt_pk_bf16_f32 v15, v38, v39
  v_add_f32_dpp v40, v40, v40 row_shr:1 row_mask:0xf bank_mask:0xf
  v_add_f32_dpp v42, v42, v42 row_shr:1 row_mask:0xf bank_mask:0xf
  s_nop 0
  v_add_f32_dpp v40, v40, v40 row_shr:2 row_mask:0xf bank_mask:0xf
  v_add_f32_dpp v42, v42, v42 row_shr:2 row_mask:0xf bank_mask:0xf
  s_nop 0
  v_add_f32_dpp v40, v40, v40 row_shr:4 row_mask:0xf bank_mask:0xf
  v_add_f32_dpp v42, v42, v42 row_shr:4 row_mask:0xf bank_mask:0xf
  s_nop 0
  v_add_f32_dpp v40, v40, v40 row_shr:8 row_mask:0xf bank_mask:0xf
  v_add_f32_dpp v42, v42, v42 row_shr:8 row_mask:0xf bank_mask:0xf
  s_nop 0
  v_add_f32_dpp v40, v40, v40 row_bcast:15 row_mask:0xa bank_mask:0xf
  v_add_f32_dpp v42, v42, v42 row_bcast:15 row_mask:0xa bank_mask:0xf
  s_nop 0
  v_add_f32_dpp v40, v40, v40 row_bcast:31 row_mask:0xc bank_mask:0xf
  v_add_f32_dpp v42, v42, v42 row_bcast:31 row_mask:0xc bank_mask:0xf
  v_mul_f32 v40, 0x3b000000, v40
  v_mul_f32 v42, 0x3b000000, v42
  v_fma_f32 v40, -v18, v18, v40
  v_fma_f32 v42, -v19, v19, v42
  v_max_f32 v40, 0, v40
  v_max_f32 v42, 0, v42
  v_cvt_pk_bf16_f32 v20, v40, v42
  v_lshlrev_b32 v40, 16, v20
  v_and_b32 v42, s81, v20
  v_add_f32 v40, 0x3727c5ac, v40
  v_add_f32 v42, 0x3727c5ac, v42
  v_cvt_pk_bf16_f32 v20, v40, v42
  v_lshlrev_b32 v40, 16, v20
  v_and_b32 v42, s81, v20
  v_sqrt_f32 v40, v40
  v_sqrt_f32 v42, v42
  v_lshlrev_b32 v24, 16, v8
  v_and_b32 v25, s81, v8
  v_lshlrev_b32 v26, 16, v9
  v_and_b32 v27, s81, v9
  v_lshlrev_b32 v28, 16, v10
  v_and_b32 v29, s81, v10
  v_lshlrev_b32 v30, 16, v11
  v_and_b32 v31, s81, v11
  v_lshlrev_b32 v32, 16, v12
  v_and_b32 v33, s81, v12
  v_lshlrev_b32 v34, 16, v13
  v_and_b32 v35, s81, v13
  v_lshlrev_b32 v36, 16, v14
  v_and_b32 v37, s81, v14
  v_lshlrev_b32 v38, 16, v15
  v_and_b32 v39, s81, v15
  v_cvt_pk_bf16_f32 v20, v40, v42
  v_lshlrev_b32 v40, 16, v20
  v_and_b32 v42, s81, v20
  v_rcp_f32 v41, v40
  v_rcp_f32 v43, v42
  v_fma_f32 v40, -v40, v41, 1.0
  v_fma_f32 v42, -v42, v43, 1.0
  v_fmac_f32 v41, v40, v41
  v_fmac_f32 v43, v42, v43
  v_readlane_b32 s74, v41, 63
  v_readlane_b32 s14, v43, 63
  s_nop 0
  v_mul_f32 v24, s74, v24
  v_mul_f32 v32, s14, v32
  v_mul_f32 v25, s74, v25
  v_mul_f32 v33, s14, v33
  v_mul_f32 v26, s74, v26
  v_mul_f32 v34, s14, v34
  v_mul_f32 v27, s74, v27
  v_mul_f32 v35, s14, v35
  v_mul_f32 v28, s74, v28
  v_mul_f32 v36, s14, v36
  v_mul_f32 v29, s74, v29
  v_mul_f32 v37, s14, v37
  v_mul_f32 v30, s74, v30
  v_mul_f32 v38, s14, v38
  v_mul_f32 v31, s74, v31
  v_mul_f32 v39, s14, v39
  v_cvt_pk_bf16_f32 v8, v24, v25
  v_cvt_pk_bf16_f32 v9, v26, v27
  v_cvt_pk_bf16_f32 v10, v28, v29
  v_cvt_pk_bf16_f32 v11, v30, v31
  v_cvt_pk_bf16_f32 v12, v32, v33
  v_cvt_pk_bf16_f32 v13, v34, v35
  v_cvt_pk_bf16_f32 v14, v36, v37
  v_cvt_pk_bf16_f32 v15, v38, v39
  ds_write_b128 v45, v[8:11]
  ds_write_b128 v45, v[12:15] offset:1088
  v_mov_b32 v22, s74
  v_mov_b32 v23, s14
  s_lshl_b32 s13, s9, 2
  s_mov_b64 exec, 1
  buffer_store_dwordx2 v[22:23], off, s[52:55], s13 sc1
  s_mov_b64 exec, -1
  s_waitcnt lgkmcnt(0)
  s_barrier
  ds_read_b64_tr_b16 v[68:69], v44 offset:4352
  ds_read_b64_tr_b16 v[70:71], v44 offset:0
  ds_read_b64_tr_b16 v[72:73], v44 offset:4480
  ds_read_b64_tr_b16 v[74:75], v44 offset:128
  s_lshl_b32 s13, s5, 13
  s_lshl_b32 s14, s7, 11
  s_add_u32 s13, s13, s14
  s_waitcnt lgkmcnt(2)
  buffer_store_dwordx4 v[68:71], v2, s[48:51], s13 offen offset:0 sc1
  s_waitcnt lgkmcnt(0)
  buffer_store_dwordx4 v[72:75], v2, s[48:51], s13 offen offset:1024 sc1
  s_mov_b32 s64, s38
  s_and_b32 s65, s39, 0xffff
  s_mov_b32 s66, 256
  s_mov_b32 s67, 0x20000
  buffer_load_dword v76, off, s[64:67], 0 sc1
  s_setprio 1
  s_bitcmp1_b32 s7, 1
  s_cselect_b32 s13, 0, 16
  s_lshl_b32 s72, s72, s13
  s_and_b32 s72, s72, 0xffff0000
  v_mov_b32 v16, s72
  s_lshl_b32 s70, s70, s13
  s_and_b32 s70, s70, 0xffff0000
  s_mov_b32 s14, 0
  s_waitcnt vmcnt(0)
Lep_13:
  v_readfirstlane_b32 s82, v76
  s_add_u32 s14, s14, 1
  s_cmp_eq_u32 s82, 0
  s_cbranch_scc1 Lepr_15
  s_sub_u32 vcc_lo, s82, s84
  s_cmp_gt_i32 vcc_lo, -1000
  s_cbranch_scc1 Lepd_14
Lepr_15:
  s_cmp_gt_u32 s14, 65536
  s_cbranch_scc1 Lepd_14
  s_sleep 4
  buffer_load_dword v76, off, s[64:67], 0 sc1
  s_waitcnt vmcnt(0)
  s_branch Lep_13
Lepd_14:
  s_barrier
  s_lshl_b32 s14, s5, 5
  s_add_u32 s14, s14, 65536
  s_cmp_lg_u32 s7, 0
  s_cbranch_scc1 Lsf_16
  v_mov_b32 v77, s82
  s_mov_b64 exec, 1
  buffer_store_dword v77, off, s[76:79], s14 sc1
  s_mov_b64 exec, -1
Lsf_16:
  v_lshlrev_b32 v4, 16, v4
  v_lshlrev_b32 v5, 16, v5
  v_lshlrev_b32 v6, 16, v6
  v_lshlrev_b32 v7, 16, v7
  v_mul_f32 v17, 0x3fb8aa3b, v16
  v_fma_f32 v18, v16, s80, -v17
  v_fmac_f32 v18, 0x32a57060, v16
  v_exp_f32 v17, v17
  v_mul_f32 v18, 0x3f317218, v18
  v_fmac_f32 v17, v17, v18
  v_cvt_pk_bf16_f32 v16, v17, v17
  v_lshlrev_b32 v16, 16, v16
  v_mul_f32 v17, 0x3fb8aa3b, v4
  v_fma_f32 v18, v4, s80, -v17
  v_fmac_f32 v18, 0x32a57060, v4
  v_exp_f32 v17, v17
  v_mul_f32 v18, 0x3f317218, v18
  v_fmac_f32 v17, v17, v18
  v_cvt_pk_bf16_f32 v4, v17, v17
  v_lshlrev_b32 v4, 16, v4
  v_mul_f32 v4, v4, v16
  v_mul_f32 v5, v5, v16
  v_mul_f32 v4, 0xbfb8aa3b, v4
  v_mul_f32 v5, 0.15915494, v5
  v_add_f32 v16, v16, v16
  v_mul_f32 v30, v6, v16
  v_mul_f32 v31, v7, v16
  v_exp_f32 v17, v4
  v_fract_f32 v18, v5
  v_cos_f32 v24, v18
  v_sin_f32 v25, v18
  v_ldexp_f32 v19, v4, 3
  v_ldexp_f32 v20, v5, 3
  v_exp_f32 v19, v19
  v_fract_f32 v20, v20
  v_cos_f32 v26, v20
  v_sin_f32 v27, v20
  v_ldexp_f32 v21, v4, 7
  v_ldexp_f32 v22, v5, 7
  v_exp_f32 v21, v21
  v_fract_f32 v22, v22
  v_cos_f32 v28, v22
  v_sin_f32 v29, v22
  v_mul_f32 v24, v24, v17
  v_mul_f32 v25, v25, v17
  v_mul_f32 v26, v26, v19
  v_mul_f32 v27, v27, v19
  v_mul_f32 v28, v28, v21
  v_mul_f32 v29, v29, v21
  s_mul_i32 s13, s7, 16416
  v_lshl_add_u32 v3, v1, 2, s13
  v_mov_b32 v8, 0x00003f80
  ds_write_b32 v3, v8 offset:0
  v_cvt_pk_bf16_f32 v9, v24, v25
  ds_write_b32 v3, v9 offset:288
  v_cvt_pk_bf16_f32 v10, v30, -v31
  ds_write_b32 v3, v10 offset:11808
  v_cvt_pk_bf16_f32 v11, v28, v29
  ds_write_b32 v3, v11 offset:2304
  v_mul_f32 v32, v30, v26
  v_mul_f32 v33, v30, v27
  v_mul_f32 v34, v28, v28
  v_mul_f32 v35, v28, v29
  v_mul_f32 v44, v24, v24
  v_mul_f32 v45, v24, v25
  v_fma_f32 v32, -v31, v27, v32
  v_fmac_f32 v33, v31, v26
  v_fma_f32 v34, -v29, v29, v34
  v_fmac_f32 v35, v29, v28
  v_fma_f32 v44, -v25, v25, v44
  v_fmac_f32 v45, v25, v24
  v_cvt_pk_bf16_f32 v12, v32, -v33
  ds_write_b32 v3, v12 offset:12096
  v_cvt_pk_bf16_f32 v13, v44, v45
  ds_write_b32 v3, v13 offset:576
  v_cvt_pk_bf16_f32 v14, v34, v35
  ds_write_b32 v3, v14 offset:4608
  v_mov_b32 v64, v34
  v_mov_b32 v65, v35
  v_mul_f32 v30, v32, v26
  v_mul_f32 v31, v32, v27
  v_mul_f32 v36, v34, v28
  v_mul_f32 v37, v34, v29
  v_mul_f32 v46, v44, v24
  v_mul_f32 v47, v44, v25
  v_fma_f32 v30, -v33, v27, v30
  v_fmac_f32 v31, v33, v26
  v_fma_f32 v36, -v35, v29, v36
  v_fmac_f32 v37, v35, v28
  v_fma_f32 v46, -v45, v25, v46
  v_fmac_f32 v47, v45, v24
  v_cvt_pk_bf16_f32 v15, v30, -v31
  ds_write_b32 v3, v15 offset:12384
  v_cvt_pk_bf16_f32 v8, v46, v47
  ds_write_b32 v3, v8 offset:864
  v_cvt_pk_bf16_f32 v9, v36, v37
  ds_write_b32 v3, v9 offset:5760
  v_mov_b32 v66, v36
  v_mov_b32 v67, v37
  v_mul_f32 v32, v30, v26
  v_mul_f32 v33, v30, v27
  v_mul_f32 v34, v36, v28
  v_mul_f32 v35, v36, v29
  v_mul_f32 v48, v46, v24
  v_mul_f32 v49, v46, v25
  v_fma_f32 v32, -v31, v27, v32
  v_fmac_f32 v33, v31, v26
  v_fma_f32 v34, -v37, v29, v34
  v_fmac_f32 v35, v37, v28
  v_fma_f32 v48, -v47, v25, v48
  v_fmac_f32 v49, v47, v24
  v_cvt_pk_bf16_f32 v10, v32, -v33
  ds_write_b32 v3, v10 offset:12672
  v_cvt_pk_bf16_f32 v11, v48, v49
  ds_write_b32 v3, v11 offset:1152
  v_cvt_pk_bf16_f32 v12, v34, v35
  ds_write_b32 v3, v12 offset:6912
  v_mul_f32 v56, v34, v48
  v_mul_f32 v57, v34, v49
  v_fma_f32 v56, -v35, v49, v56
  v_fmac_f32 v57, v35, v48
  v_cvt_pk_bf16_f32 v13, v56, v57
  ds_write_b32 v3, v13 offset:7200
  v_mul_f32 v30, v32, v26
  v_mul_f32 v31, v32, v27
  v_mul_f32 v36, v34, v28
  v_mul_f32 v37, v34, v29
  v_mul_f32 v50, v48, v24
  v_mul_f32 v51, v48, v25
  v_fma_f32 v30, -v33, v27, v30
  v_fmac_f32 v31, v33, v26
  v_fma_f32 v36, -v35, v29, v36
  v_fmac_f32 v37, v35, v28
  v_fma_f32 v50, -v49, v25, v50
  v_fmac_f32 v51, v49, v24
  v_cvt_pk_bf16_f32 v14, v30, -v31
  ds_write_b32 v3, v14 offset:12960
  v_cvt_pk_bf16_f32 v15, v50, v51
  ds_write_b32 v3, v15 offset:1440
  v_cvt_pk_bf16_f32 v8, v36, v37
  ds_write_b32 v3, v8 offset:7488
  v_mul_f32 v58, v36, v48
  v_mul_f32 v59, v36, v49
  v_fma_f32 v58, -v37, v49, v58
  v_fmac_f32 v59, v37, v48
  v_cvt_pk_bf16_f32 v9, v58, v59
  ds_write_b32 v3, v9 offset:7776
  v_mul_f32 v32, v30, v26
  v_mul_f32 v33, v30, v27
  v_mul_f32 v34, v36, v28
  v_mul_f32 v35, v36, v29
  v_mul_f32 v52, v50, v24
  v_mul_f32 v53, v50, v25
  v_fma_f32 v32, -v31, v27, v32
  v_fmac_f32 v33, v31, v26
  v_fma_f32 v34, -v37, v29, v34
  v_fmac_f32 v35, v37, v28
  v_fma_f32 v52, -v51, v25, v52
  v_fmac_f32 v53, v51, v24
  v_cvt_pk_bf16_f32 v10, v32, -v33
  ds_write_b32 v3, v10 offset:13248
  v_cvt_pk_bf16_f32 v11, v52, v53
  ds_write_b32 v3, v11 offset:1728
  v_cvt_pk_bf16_f32 v12, v34, v35
  ds_write_b32 v3, v12 offset:8064
  v_mul_f32 v60, v34, v48
  v_mul_f32 v61, v34, v49
  v_fma_f32 v60, -v35, v49, v60
  v_fmac_f32 v61, v35, v48
  v_cvt_pk_bf16_f32 v13, v60, v61
  ds_write_b32 v3, v13 offset:8352
  v_mul_f32 v30, v32, v26
  v_mul_f32 v31, v32, v27
  v_mul_f32 v36, v34, v28
  v_mul_f32 v37, v34, v29
  v_mul_f32 v54, v52, v24
  v_mul_f32 v55, v52, v25
  v_fma_f32 v30, -v33, v27, v30
  v_fmac_f32 v31, v33, v26
  v_fma_f32 v36, -v35, v29, v36
  v_fmac_f32 v37, v35, v28
  v_fma_f32 v54, -v53, v25, v54
  v_fmac_f32 v55, v53, v24
  v_cvt_pk_bf16_f32 v14, v30, -v31
  ds_write_b32 v3, v14 offset:13536
  v_cvt_pk_bf16_f32 v15, v54, v55
  ds_write_b32 v3, v15 offset:2016
  v_cvt_pk_bf16_f32 v8, v36, v37
  ds_write_b32 v3, v8 offset:8640
  v_mul_f32 v62, v36, v48
  v_mul_f32 v63, v36, v49
  v_fma_f32 v62, -v37, v49, v62
  v_fmac_f32 v63, v37, v48
  v_cvt_pk_bf16_f32 v9, v62, v63
  ds_write_b32 v3, v9 offset:8928
  v_mul_f32 v32, v30, v26
  v_mul_f32 v33, v30, v27
  v_mul_f32 v34, v36, v28
  v_mul_f32 v35, v36, v29
  v_fma_f32 v32, -v31, v27, v32
  v_fmac_f32 v33, v31, v26
  v_fma_f32 v34, -v37, v29, v34
  v_fmac_f32 v35, v37, v28
  v_cvt_pk_bf16_f32 v10, v32, -v33
  ds_write_b32 v3, v10 offset:13824
  v_cvt_pk_bf16_f32 v11, v34, v35
  ds_write_b32 v3, v11 offset:9216
  v_mul_f32 v56, v28, v24
  v_mul_f32 v57, v28, v25
  v_mul_f32 v58, v28, v44
  v_mul_f32 v59, v28, v45
  v_mul_f32 v60, v28, v46
  v_mul_f32 v61, v28, v47
  v_mul_f32 v62, v28, v48
  v_mul_f32 v63, v28, v49
  v_fma_f32 v56, -v29, v25, v56
  v_fmac_f32 v57, v29, v24
  v_fma_f32 v58, -v29, v45, v58
  v_fmac_f32 v59, v29, v44
  v_fma_f32 v60, -v29, v47, v60
  v_fmac_f32 v61, v29, v46
  v_fma_f32 v62, -v29, v49, v62
  v_fmac_f32 v63, v29, v48
  v_cvt_pk_bf16_f32 v12, v56, v57
  ds_write_b32 v3, v12 offset:2592
  v_cvt_pk_bf16_f32 v13, v58, v59
  ds_write_b32 v3, v13 offset:2880
  v_cvt_pk_bf16_f32 v14, v60, v61
  ds_write_b32 v3, v14 offset:3168
  v_cvt_pk_bf16_f32 v15, v62, v63
  ds_write_b32 v3, v15 offset:3456
  v_mul_f32 v30, v32, v26
  v_mul_f32 v31, v32, v27
  v_mul_f32 v36, v34, v28
  v_mul_f32 v37, v34, v29
  v_fma_f32 v30, -v33, v27, v30
  v_fmac_f32 v31, v33, v26
  v_fma_f32 v36, -v35, v29, v36
  v_fmac_f32 v37, v35, v28
  v_cvt_pk_bf16_f32 v8, v30, -v31
  ds_write_b32 v3, v8 offset:14112
  v_cvt_pk_bf16_f32 v9, v36, v37
  ds_write_b32 v3, v9 offset:9504
  v_mul_f32 v56, v28, v50
  v_mul_f32 v57, v28, v51
  v_mul_f32 v58, v28, v52
  v_mul_f32 v59, v28, v53
  v_mul_f32 v60, v28, v54
  v_mul_f32 v61, v28, v55
  v_fma_f32 v56, -v29, v51, v56
  v_fmac_f32 v57, v29, v50
  v_fma_f32 v58, -v29, v53, v58
  v_fmac_f32 v59, v29, v52
  v_fma_f32 v60, -v29, v55, v60
  v_fmac_f32 v61, v29, v54
  v_cvt_pk_bf16_f32 v10, v56, v57
  ds_write_b32 v3, v10 offset:3744
  v_cvt_pk_bf16_f32 v11, v58, v59
  ds_write_b32 v3, v11 offset:4032
  v_cvt_pk_bf16_f32 v12, v60, v61
  ds_write_b32 v3, v12 offset:4320
  v_lshlrev_b32 v104, 5, v1
  s_mov_b32 s14, 0
  s_cmp_lg_u32 s7, 0
  s_cbranch_scc1 Lpld_18
Lpl_17:
  s_mov_b32 s15, 65536
  buffer_load_dword v96, v104, s[76:79], s15 offen sc1
  s_mov_b32 s15, 67584
  buffer_load_dword v97, v104, s[76:79], s15 offen sc1
  s_mov_b32 s15, 69632
  buffer_load_dword v98, v104, s[76:79], s15 offen sc1
  s_mov_b32 s15, 71680
  buffer_load_dword v99, v104, s[76:79], s15 offen sc1
  s_add_u32 s14, s14, 1
  s_waitcnt vmcnt(0)
  v_xor_b32 v96, s82, v96
  v_xor_b32 v97, s82, v97
  v_xor_b32 v98, s82, v98
  v_xor_b32 v99, s82, v99
  v_or3_b32 v96, v96, v97, v98
  v_or_b32 v96, v96, v99
  v_cmp_ne_u32 vcc, 0, v96
  s_cbranch_vccz Lpld_18
  s_cmp_gt_u32 s14, 65536
  s_cbranch_scc1 Lpld_18
  s_sleep 8
  s_branch Lpl_17
Lpld_18:
  s_barrier
  s_lshl_b32 s14, s6, 4
  v_lshrrev_b32 v104, 1, v1
  v_lshlrev_b32 v104, 13, v104
  v_and_b32 v105, 1, v1
  v_lshl_add_u32 v104, v105, 4, v104
  v_add_u32 v104, s14, v104
  s_lshl_b32 s14, s7, 19
  buffer_load_dwordx4 v[96:99], v104, s[48:51], s14 offen sc1
  s_add_u32 s14, s14, 0x40000
  buffer_load_dwordx4 v[100:103], v104, s[48:51], s14 offen sc1
  v_mul_u32_u24 v105, 4576, v105
  v_lshrrev_b32 v104, 1, v1
  v_lshl_add_u32 v105, v104, 4, v105
  s_lshl_b32 s14, s7, 10
  s_add_u32 s14, s14, 66976
  v_add_u32 v105, s14, v105
  v_mul_f32 v32, v30, v26
  v_mul_f32 v33, v30, v27
  v_mul_f32 v34, v36, v28
  v_mul_f32 v35, v36, v29
  v_fma_f32 v32, -v31, v27, v32
  v_fmac_f32 v33, v31, v26
  v_fma_f32 v34, -v37, v29, v34
  v_fmac_f32 v35, v37, v28
  v_cvt_pk_bf16_f32 v13, v32, -v33
  ds_write_b32 v3, v13 offset:14400
  v_cvt_pk_bf16_f32 v14, v34, v35
  ds_write_b32 v3, v14 offset:9792
  v_mul_f32 v62, v64, v44
  v_mul_f32 v63, v64, v45
  v_mul_f32 v56, v64, v48
  v_mul_f32 v57, v64, v49
  v_mul_f32 v58, v64, v52
  v_mul_f32 v59, v64, v53
  v_fma_f32 v62, -v65, v45, v62
  v_fmac_f32 v63, v65, v44
  v_fma_f32 v56, -v65, v49, v56
  v_fmac_f32 v57, v65, v48
  v_fma_f32 v58, -v65, v53, v58
  v_fmac_f32 v59, v65, v52
  v_cvt_pk_bf16_f32 v15, v62, v63
  ds_write_b32 v3, v15 offset:4896
  v_cvt_pk_bf16_f32 v8, v56, v57
  ds_write_b32 v3, v8 offset:5184
  v_cvt_pk_bf16_f32 v9, v58, v59
  ds_write_b32 v3, v9 offset:5472
  v_mul_f32 v30, v32, v26
  v_mul_f32 v31, v32, v27
  v_mul_f32 v36, v34, v28
  v_mul_f32 v37, v34, v29
  v_fma_f32 v30, -v33, v27, v30
  v_fmac_f32 v31, v33, v26
  v_fma_f32 v36, -v35, v29, v36
  v_fmac_f32 v37, v35, v28
  v_cvt_pk_bf16_f32 v10, v30, -v31
  ds_write_b32 v3, v10 offset:14688
  v_cvt_pk_bf16_f32 v11, v36, v37
  ds_write_b32 v3, v11 offset:10080
  v_mul_f32 v60, v66, v44
  v_mul_f32 v61, v66, v45
  v_mul_f32 v62, v66, v48
  v_mul_f32 v63, v66, v49
  v_mul_f32 v56, v66, v52
  v_mul_f32 v57, v66, v53
  v_fma_f32 v60, -v67, v45, v60
  v_fmac_f32 v61, v67, v44
  v_fma_f32 v62, -v67, v49, v62
  v_fmac_f32 v63, v67, v48
  v_fma_f32 v56, -v67, v53, v56
  v_fmac_f32 v57, v67, v52
  v_cvt_pk_bf16_f32 v12, v60, v61
  ds_write_b32 v3, v12 offset:6048
  v_cvt_pk_bf16_f32 v13, v62, v63
  ds_write_b32 v3, v13 offset:6336
  v_cvt_pk_bf16_f32 v14, v56, v57
  ds_write_b32 v3, v14 offset:6624
  v_mul_f32 v32, v30, v26
  v_mul_f32 v33, v30, v27
  v_mul_f32 v34, v36, v28
  v_mul_f32 v35, v36, v29
  v_fma_f32 v32, -v31, v27, v32
  v_fmac_f32 v33, v31, v26
  v_fma_f32 v34, -v37, v29, v34
  v_fmac_f32 v35, v37, v28
  v_cvt_pk_bf16_f32 v15, v32, -v33
  ds_write_b32 v3, v15 offset:14976
  v_cvt_pk_bf16_f32 v8, v34, v35
  ds_write_b32 v3, v8 offset:10368
  v_mul_f32 v30, v32, v26
  v_mul_f32 v31, v32, v27
  v_mul_f32 v36, v34, v28
  v_mul_f32 v37, v34, v29
  v_fma_f32 v30, -v33, v27, v30
  v_fmac_f32 v31, v33, v26
  v_fma_f32 v36, -v35, v29, v36
  v_fmac_f32 v37, v35, v28
  v_cvt_pk_bf16_f32 v9, v30, -v31
  ds_write_b32 v3, v9 offset:15264
  v_cvt_pk_bf16_f32 v10, v36, v37
  ds_write_b32 v3, v10 offset:10656
  v_mul_f32 v32, v30, v26
  v_mul_f32 v33, v30, v27
  v_mul_f32 v34, v36, v28
  v_mul_f32 v35, v36, v29
  v_fma_f32 v32, -v31, v27, v32
  v_fmac_f32 v33, v31, v26
  v_fma_f32 v34, -v37, v29, v34
  v_fmac_f32 v35, v37, v28
  v_cvt_pk_bf16_f32 v11, v32, -v33
  ds_write_b32 v3, v11 offset:15552
  v_cvt_pk_bf16_f32 v12, v34, v35
  ds_write_b32 v3, v12 offset:10944
  v_mul_f32 v30, v32, v26
  v_mul_f32 v31, v32, v27
  v_mul_f32 v36, v34, v28
  v_mul_f32 v37, v34, v29
  v_fma_f32 v30, -v33, v27, v30
  v_fmac_f32 v31, v33, v26
  v_fma_f32 v36, -v35, v29, v36
  v_fmac_f32 v37, v35, v28
  v_cvt_pk_bf16_f32 v13, v30, -v31
  ds_write_b32 v3, v13 offset:15840
  v_cvt_pk_bf16_f32 v14, v36, v37
  ds_write_b32 v3, v14 offset:11232
  v_mul_f32 v32, v30, v26
  v_mul_f32 v33, v30, v27
  v_mul_f32 v34, v36, v28
  v_mul_f32 v35, v36, v29
  v_fma_f32 v32, -v31, v27, v32
  v_fmac_f32 v33, v31, v26
  v_fma_f32 v34, -v37, v29, v34
  v_fmac_f32 v35, v37, v28
  v_cvt_pk_bf16_f32 v15, v32, -v33
  ds_write_b32 v3, v15 offset:16128
  v_cvt_pk_bf16_f32 v8, v34, v35
  ds_write_b32 v3, v8 offset:11520
  v_and_b32 v4, 15, v1
  v_mul_u32_u24 v4, 288, v4
  v_lshrrev_b32 v5, 4, v1
  v_lshl_add_u32 v4, v5, 4, v4
  v_add_u32 v4, s13, v4
  s_waitcnt lgkmcnt(0)
  s_setprio 1
  ds_read_b128 v[24:27], v4 offset:11808
  ds_read_b128 v[28:31], v4 offset:0
  ds_read_b128 v[32:35], v4 offset:4608
  ds_read_b128 v[36:39], v4 offset:9216
  ds_read_b128 v[40:43], v4 offset:11872
  ds_read_b128 v[44:47], v4 offset:64
  ds_read_b128 v[48:51], v4 offset:4672
  ds_read_b128 v[52:55], v4 offset:9280
  ds_read_b128 v[56:59], v4 offset:11936
  ds_read_b128 v[60:63], v4 offset:128
  ds_read_b128 v[64:67], v4 offset:4736
  ds_read_b128 v[68:71], v4 offset:9344
  ds_read_b128 v[72:75], v4 offset:12000
  ds_read_b128 v[76:79], v4 offset:192
  ds_read_b128 v[80:83], v4 offset:4800
  ds_read_b128 v[84:87], v4 offset:9408
  s_waitcnt lgkmcnt(12)
  v_mfma_f32_16x16x32_bf16 v[8:11], v[28:31], v[24:27], 0
  v_mfma_f32_16x16x32_bf16 v[12:15], v[32:35], v[24:27], 0
  v_mfma_f32_16x16x32_bf16 v[16:19], v[36:39], v[24:27], 0
  s_waitcnt lgkmcnt(8)
  v_mfma_f32_16x16x32_bf16 v[8:11], v[44:47], v[40:43], v[8:11]
  v_mfma_f32_16x16x32_bf16 v[12:15], v[48:51], v[40:43], v[12:15]
  v_mfma_f32_16x16x32_bf16 v[16:19], v[52:55], v[40:43], v[16:19]
  s_waitcnt lgkmcnt(4)
  v_mfma_f32_16x16x32_bf16 v[8:11], v[60:63], v[56:59], v[8:11]
  v_mfma_f32_16x16x32_bf16 v[12:15], v[64:67], v[56:59], v[12:15]
  v_mfma_f32_16x16x32_bf16 v[16:19], v[68:71], v[56:59], v[16:19]
  s_waitcnt lgkmcnt(0)
  v_mfma_f32_16x16x32_bf16 v[8:11], v[76:79], v[72:75], v[8:11]
  v_mfma_f32_16x16x32_bf16 v[12:15], v[80:83], v[72:75], v[12:15]
  v_mfma_f32_16x16x32_bf16 v[16:19], v[84:87], v[72:75], v[16:19]
  s_mul_i32 s10, s42, 4576
  s_add_u32 s10, s10, 66496
  s_mul_i32 s11, s42, 33248
  s_lshl_b32 s12, s42, 11
  s_add_u32 s12, s12, 75648
  v_and_b32 v4, 15, v1
  v_lshrrev_b32 v6, 1, v5
  v_lshlrev_b32 v6, 8, v6
  v_and_b32 v7, 1, v5
  v_lshl_add_u32 v6, v7, 3, v6
  v_lshl_add_u32 v6, v4, 4, v6
  v_add_u32 v6, s12, v6
  v_cmp_gt_u32 vcc, 2, v5
  v_lshlrev_b32 v20, 2, v4
  v_lshlrev_b32 v21, 3, v4
  v_cndmask_b32 v20, v20, v21, vcc
  v_lshl_add_u32 v20, v5, 7, v20
  v_add_u32 v20, s12, v20
  v_mov_b32 v21, 64
  v_cndmask_b32 v21, v21, 4, vcc
  v_add_u32 v21, v21, v20
  v_lshlrev_b32 v22, 1, v4
  v_lshl_add_u32 v22, v5, 7, v22
  v_add_u32 v22, s12, v22
  v_add_u32 v23, s13, v2
  s_bitcmp1_b32 s7, 0
  s_cbranch_scc0 Lkeven_19
  ds_write_b128 v23, v[8:11] offset:0
  ds_write_b128 v23, v[12:15] offset:1024
  ds_write_b128 v23, v[16:19] offset:2048
  s_waitcnt lgkmcnt(0)
  s_barrier
  s_branch Lkjoin_20
Lkeven_19:
  s_barrier
  ds_read_b128 v[24:27], v23 offset:16416
  ds_read_b128 v[28:31], v23 offset:17440
  ds_read_b128 v[32:35], v23 offset:18464
  s_waitcnt lgkmcnt(0)
  v_pk_add_f32 v[8:9], v[8:9], v[24:25]
  v_pk_add_f32 v[10:11], v[10:11], v[26:27]
  v_pk_add_f32 v[12:13], v[12:13], v[28:29]
  v_pk_add_f32 v[14:15], v[14:15], v[30:31]
  v_pk_add_f32 v[16:17], v[16:17], v[32:33]
  v_pk_add_f32 v[18:19], v[18:19], v[34:35]
  v_cvt_pk_bf16_f32 v24, v8, v9
  v_cvt_pk_bf16_f32 v25, v10, v11
  v_cvt_pk_bf16_f32 v26, v12, v13
  v_cvt_pk_bf16_f32 v27, v14, v15
  v_cvt_pk_bf16_f32 v28, v16, v17
  v_cvt_pk_bf16_f32 v29, v18, v19
  ds_write_b64 v6, v[24:25]
  ds_write_b32 v20, v26 offset:512
  ds_write_b32 v21, v27 offset:512
  ds_write_b16 v22, v28 offset:1024
  ds_write_b16_d16_hi v22, v28 offset:1056
  ds_write_b16 v22, v29 offset:1088
  ds_write_b16_d16_hi v22, v29 offset:1120
Lkjoin_20:
  s_mov_b32 s60, 135331852
  s_mov_b32 s61, 33816579
  v_mov_b32 v4, 471139353
  v_mov_b32 v5, 117768454
  v_mov_b32 v8, 0
  v_mov_b32 v9, 0
  v_mov_b32 v10, 0
  v_mov_b32 v11, 0
  v_and_b32 v6, 7, v1
  v_or_b32 v12, 0x0c0c0c00, v6
  v_perm_b32 v7, v4, s60, v12
  v_perm_b32 v12, v5, s61, v12
  v_lshl_or_b32 v7, v12, 8, v7
  v_lshrrev_b32 v6, 3, v1
  v_add_u32 v7, v7, v6
  v_lshlrev_b32 v7, 4, v7
  v_add_u32 v7, s11, v7
  v_add_u32 v6, s10, v2
  v_and_b32 v12, 62, v1
  v_lshlrev_b32 v12, 1, v12
  s_lshl_b32 s14, s43, 7
  s_add_u32 s14, s14, s12
  s_add_u32 s14, s14, 1024
  v_add_u32 v12, s14, v12
  v_and_b32 v13, 1, v1
  v_cmp_eq_u32 vcc, 1, v13
  v_mov_b32 v13, 0x01000100
  v_mov_b32 v14, 0x03020100
  v_mov_b32 v15, 0x03020302
  v_mov_b32 v16, 0x05040504
  v_cndmask_b32 v17, v13, v15, vcc
  v_cndmask_b32 v18, v14, v16, vcc
  v_cndmask_b32 v19, v15, v16, vcc
  v_cmp_gt_u32 vcc, 32, v1
  v_lshlrev_b32 v20, 3, v1
  v_add_u32 v20, 256, v20
  v_add_u32 v21, 4, v20
  v_add_u32 v22, 8, v2
  v_cndmask_b32 v20, v20, v2, vcc
  v_cndmask_b32 v21, v21, v22, vcc
  v_mov_b32 v22, 0x05040302
  v_mov_b32 v23, 0x07060504
  v_cndmask_b32 v24, v13, v14, vcc
  v_cndmask_b32 v25, v22, v23, vcc
  v_mov_b32 v26, v24
  v_mov_b32 v27, v25
  s_cmp_eq_u32 s43, 1
  s_cbranch_scc1 Lcp1_21
  v_lshlrev_b32 v20, 2, v1
  v_add_u32 v20, 768, v20
  v_mov_b32 v21, v20
  v_mov_b32 v24, v13
  v_mov_b32 v25, v14
  v_mov_b32 v26, v15
  v_mov_b32 v27, v16
Lcp1_21:
  v_add_u32 v20, s12, v20
  v_add_u32 v21, s12, v21
  s_lshl_b32 s14, s43, 10
  s_add_u32 s15, s11, s14
  v_add_u32 v28, s15, v2
  s_sub_u32 s15, s11, s14
  s_add_u32 s15, s15, 1024
  v_add_u32 v29, s15, v2
  s_waitcnt lgkmcnt(0)
  s_barrier
  s_mov_b64 exec, 0x1ff
  ds_write_b128 v7, v[8:11]
  s_mov_b64 exec, 0x3fffffff
  ds_write_b128 v6, v[8:11]
  s_mov_b64 exec, -1
  ds_read2_b32 v[32:33], v12 offset0:0 offset1:1
  ds_read2_b32 v[34:35], v20 offset0:0 offset1:1
  ds_read2_b32 v[36:37], v21 offset0:0 offset1:1
  s_waitcnt lgkmcnt(2)
  v_perm_b32 v40, v33, v32, v17
  v_perm_b32 v42, v33, v32, v18
  v_perm_b32 v43, v33, v32, v19
  v_mov_b32 v41, v40
  ds_write_b128 v28, v[40:43] offset:14560
  s_waitcnt lgkmcnt(1)
  v_perm_b32 v44, v35, v34, v24
  v_perm_b32 v45, v35, v34, v25
  v_perm_b32 v46, v37, v36, v26
  v_perm_b32 v47, v37, v36, v27
  ds_write_b128 v29, v[44:47] offset:12512
  s_lshl_b32 s14, s43, 11
  s_add_u32 s15, s14, s10
  v_add_u32 v29, s15, v2
  s_add_u32 s14, s14, s11
  v_add_u32 v28, s14, v2
  v_and_b32 v6, 15, v1
  v_add_u32 v12, 1, v6
  v_and_b32 v13, 7, v12
  v_or_b32 v14, 0x0c0c0c00, v13
  v_perm_b32 v7, v4, s60, v14
  v_perm_b32 v14, v5, s61, v14
  v_lshl_or_b32 v7, v14, 8, v7
  v_lshrrev_b32 v12, 3, v12
  v_lshrrev_b32 v13, 4, v1
  v_sub_u32 v12, v12, v13
  v_add3_u32 v7, v7, v12, 3
  v_lshlrev_b32 v7, 4, v7
  s_lshl_b32 s14, s43, 8
  s_add_u32 s15, s14, s11
  v_add_u32 v7, s15, v7
  v_lshl_add_u32 v6, v6, 1, v13
  v_lshlrev_b32 v6, 4, v6
  s_sub_u32 s15, s10, s14
  s_add_u32 s15, s15, 256
  v_add_u32 v6, s15, v6
  s_waitcnt lgkmcnt(0)
  s_barrier
  ds_read_b128 v[32:35], v28 offset:12496
  ds_read_b128 v[36:39], v28 offset:12512
  ds_read_b128 v[64:67], v28 offset:13520
  ds_read_b128 v[68:71], v28 offset:13536
  s_waitcnt lgkmcnt(2)
  ds_write_b128 v28, v[34:37] offset:24992
  v_alignbit_b32 v46, v33, v32, 16
  v_alignbit_b32 v47, v34, v33, 16
  v_alignbit_b32 v48, v35, v34, 16
  v_alignbit_b32 v49, v36, v35, 16
  v_alignbit_b32 v50, v37, v36, 16
  v_alignbit_b32 v51, v38, v37, 16
  ds_write_b128 v28, v[46:49] offset:16
  ds_write_b128 v28, v[48:51] offset:4176
  v_mov_b32 v40, v33
  v_mov_b32 v41, v34
  v_mov_b32 v42, v35
  v_mov_b32 v43, v36
  v_mov_b32 v44, v37
  v_mov_b32 v45, v38
  ds_write_b128 v28, v[40:43] offset:16672
  ds_write_b128 v28, v[42:45] offset:20832
  v_alignbit_b32 v52, v34, v33, 16
  v_alignbit_b32 v53, v35, v34, 16
  v_alignbit_b32 v54, v36, v35, 16
  v_alignbit_b32 v55, v37, v36, 16
  v_alignbit_b32 v56, v38, v37, 16
  v_alignbit_b32 v57, v39, v38, 16
  ds_write_b128 v28, v[52:55] offset:8336
  ds_write_b128 v28, v[54:57] offset:29136
  s_waitcnt lgkmcnt(7)
  ds_write_b128 v28, v[66:69] offset:26016
  v_alignbit_b32 v78, v65, v64, 16
  v_alignbit_b32 v79, v66, v65, 16
  v_alignbit_b32 v80, v67, v66, 16
  v_alignbit_b32 v81, v68, v67, 16
  v_alignbit_b32 v82, v69, v68, 16
  v_alignbit_b32 v83, v70, v69, 16
  ds_write_b128 v28, v[78:81] offset:1040
  ds_write_b128 v28, v[80:83] offset:5200
  v_mov_b32 v72, v65
  v_mov_b32 v73, v66
  v_mov_b32 v74, v67
  v_mov_b32 v75, v68
  v_mov_b32 v76, v69
  v_mov_b32 v77, v70
  ds_write_b128 v28, v[72:75] offset:17696
  ds_write_b128 v28, v[74:77] offset:21856
  v_alignbit_b32 v84, v66, v65, 16
  v_alignbit_b32 v85, v67, v66, 16
  v_alignbit_b32 v86, v68, v67, 16
  v_alignbit_b32 v87, v69, v68, 16
  v_alignbit_b32 v88, v70, v69, 16
  v_alignbit_b32 v89, v71, v70, 16
  ds_write_b128 v28, v[84:87] offset:9360
  ds_write_b128 v28, v[86:89] offset:30160
  s_waitcnt vmcnt(0)
  ds_write_b128 v105, v[96:99]
  ds_write_b128 v105, v[100:103] offset:512
  s_waitcnt lgkmcnt(0)
  s_barrier
  ds_read_b128 v[64:67], v6 offset:192
  ds_read_b128 v[96:99], v7 offset:0
  ds_read_b128 v[68:71], v6 offset:704
  ds_read_b128 v[72:75], v6 offset:1216
  ds_read_b128 v[76:79], v6 offset:1728
  ds_read_b128 v[80:83], v6 offset:2240
  ds_read_b128 v[84:87], v6 offset:2752
  ds_read_b128 v[88:91], v6 offset:3264
  ds_read_b128 v[92:95], v6 offset:3776
  ds_read_b128 v[100:103], v7 offset:512
  ds_read_b128 v[104:107], v7 offset:1024
  ds_read_b128 v[108:111], v7 offset:1536
  ds_read_b128 v[112:115], v7 offset:2048
  ds_read_b128 v[116:119], v7 offset:2560
  ds_read_b128 v[120:123], v7 offset:3072
  ds_read_b128 v[124:127], v7 offset:3584
  s_waitcnt lgkmcnt(7)
  v_mfma_f32_16x16x32_bf16 v[32:35], v[96:99], v[64:67], 0
  s_lshl_b32 s14, s7, 12
  v_mfma_f32_16x16x32_bf16 v[36:39], v[96:99], v[68:71], 0
  v_add_u32 v28, s14, v2
  v_mfma_f32_16x16x32_bf16 v[40:43], v[96:99], v[72:75], 0
  s_xor_b32 s14, s14, 4096
  v_mfma_f32_16x16x32_bf16 v[44:47], v[96:99], v[76:79], 0
  v_add_u32 v29, s14, v2
  v_mfma_f32_16x16x32_bf16 v[48:51], v[96:99], v[80:83], 0
  v_and_b32 v12, 15, v1
  v_mfma_f32_16x16x32_bf16 v[52:55], v[96:99], v[84:87], 0
  v_lshrrev_b32 v13, 5, v1
  v_mfma_f32_16x16x32_bf16 v[56:59], v[96:99], v[88:91], 0
  v_lshl_add_u32 v14, v12, 1, v13
  v_mfma_f32_16x16x32_bf16 v[60:63], v[96:99], v[92:95], 0
  v_lshlrev_b32 v14, 4, v14
  s_waitcnt lgkmcnt(6)
  v_mfma_f32_16x16x32_bf16 v[36:39], v[100:103], v[64:67], v[36:39]
  ds_read_b128 v[128:131], v6 offset:128
  v_mfma_f32_16x16x32_bf16 v[40:43], v[100:103], v[68:71], v[40:43]
  ds_read_b128 v[160:163], v7 offset:64
  v_mfma_f32_16x16x32_bf16 v[44:47], v[100:103], v[72:75], v[44:47]
  ds_read_b128 v[132:135], v6 offset:640
  v_mfma_f32_16x16x32_bf16 v[48:51], v[100:103], v[76:79], v[48:51]
  ds_read_b128 v[136:139], v6 offset:1152
  v_mfma_f32_16x16x32_bf16 v[52:55], v[100:103], v[80:83], v[52:55]
  ds_read_b128 v[140:143], v6 offset:1664
  v_mfma_f32_16x16x32_bf16 v[56:59], v[100:103], v[84:87], v[56:59]
  ds_read_b128 v[144:147], v6 offset:2176
  v_mfma_f32_16x16x32_bf16 v[60:63], v[100:103], v[88:91], v[60:63]
  ds_read_b128 v[148:151], v6 offset:2688
  s_waitcnt lgkmcnt(12)
  v_mfma_f32_16x16x32_bf16 v[40:43], v[104:107], v[64:67], v[40:43]
  ds_read_b128 v[152:155], v6 offset:3200
  v_mfma_f32_16x16x32_bf16 v[44:47], v[104:107], v[68:71], v[44:47]
  ds_read_b128 v[156:159], v6 offset:3712
  v_mfma_f32_16x16x32_bf16 v[48:51], v[104:107], v[72:75], v[48:51]
  ds_read_b128 v[164:167], v7 offset:576
  v_mfma_f32_16x16x32_bf16 v[52:55], v[104:107], v[76:79], v[52:55]
  ds_read_b128 v[168:171], v7 offset:1088
  v_mfma_f32_16x16x32_bf16 v[56:59], v[104:107], v[80:83], v[56:59]
  ds_read_b128 v[172:175], v7 offset:1600
  v_mfma_f32_16x16x32_bf16 v[60:63], v[104:107], v[84:87], v[60:63]
  ds_read_b128 v[176:179], v7 offset:2112
  s_waitcnt lgkmcnt(15)
  v_mfma_f32_16x16x32_bf16 v[44:47], v[108:111], v[64:67], v[44:47]
  ds_read_b128 v[180:183], v7 offset:2624
  v_mfma_f32_16x16x32_bf16 v[48:51], v[108:111], v[68:71], v[48:51]
  ds_read_b128 v[184:187], v7 offset:3136
  v_mfma_f32_16x16x32_bf16 v[52:55], v[108:111], v[72:75], v[52:55]
  ds_read_b128 v[188:191], v7 offset:3648
  v_mfma_f32_16x16x32_bf16 v[56:59], v[108:111], v[76:79], v[56:59]
  v_bfe_u32 v13, v1, 4, 1
  v_xor_b32 v13, 1, v13
  v_mfma_f32_16x16x32_bf16 v[60:63], v[108:111], v[80:83], v[60:63]
  v_lshl_add_u32 v14, v13, 3, v14
  s_lshl_b32 s14, s43, 11
  v_mfma_f32_16x16x32_bf16 v[48:51], v[112:115], v[64:67], v[48:51]
  s_add_u32 s14, s14, s10
  v_add_u32 v14, s14, v14
  v_mfma_f32_16x16x32_bf16 v[52:55], v[112:115], v[68:71], v[52:55]
  ds_read_b64 v[16:17], v14 offset:480
  ds_read_b64 v[18:19], v14 offset:992
  v_mfma_f32_16x16x32_bf16 v[56:59], v[112:115], v[72:75], v[56:59]
  ds_read_b64 v[20:21], v14 offset:1504
  ds_read_b64 v[22:23], v14 offset:2016
  v_mfma_f32_16x16x32_bf16 v[60:63], v[112:115], v[76:79], v[60:63]
  v_mfma_f32_16x16x32_bf16 v[52:55], v[116:119], v[64:67], v[52:55]
  v_mfma_f32_16x16x32_bf16 v[56:59], v[116:119], v[68:71], v[56:59]
  v_mfma_f32_16x16x32_bf16 v[60:63], v[116:119], v[72:75], v[60:63]
  s_waitcnt lgkmcnt(15)
  v_mfma_f32_16x16x32_bf16 v[56:59], v[120:123], v[64:67], v[56:59]
  v_mfma_f32_16x16x32_bf16 v[60:63], v[120:123], v[68:71], v[60:63]
  v_mfma_f32_16x16x32_bf16 v[60:63], v[124:127], v[64:67], v[60:63]
  s_waitcnt lgkmcnt(11)
  v_mfma_f32_16x16x32_bf16 v[32:35], v[160:163], v[128:131], v[32:35]
  v_lshrrev_b32 v13, 2, v12
  v_mfma_f32_16x16x32_bf16 v[36:39], v[160:163], v[132:135], v[36:39]
  v_lshlrev_b32 v13, 16, v13
  v_mfma_f32_16x16x32_bf16 v[40:43], v[160:163], v[136:139], v[40:43]
  v_and_b32 v12, 3, v12
  v_mfma_f32_16x16x32_bf16 v[44:47], v[160:163], v[140:143], v[44:47]
  v_lshl_add_u32 v13, v12, 5, v13
  v_mfma_f32_16x16x32_bf16 v[48:51], v[160:163], v[144:147], v[48:51]
  v_lshrrev_b32 v12, 4, v1
  v_mfma_f32_16x16x32_bf16 v[52:55], v[160:163], v[148:151], v[52:55]
  v_lshl_add_u32 v13, v12, 3, v13
  v_mfma_f32_16x16x32_bf16 v[56:59], v[160:163], v[152:155], v[56:59]
  s_lshl_b32 s14, s43, 20
  v_mfma_f32_16x16x32_bf16 v[60:63], v[160:163], v[156:159], v[60:63]
  s_lshl_b32 s15, s8, 7
  s_waitcnt lgkmcnt(10)
  v_mfma_f32_16x16x32_bf16 v[36:39], v[164:167], v[128:131], v[36:39]
  ds_read_b128 v[64:67], v6 offset:64
  v_mfma_f32_16x16x32_bf16 v[40:43], v[164:167], v[132:135], v[40:43]
  ds_read_b128 v[96:99], v7 offset:128
  v_mfma_f32_16x16x32_bf16 v[44:47], v[164:167], v[136:139], v[44:47]
  ds_read_b128 v[68:71], v6 offset:576
  v_mfma_f32_16x16x32_bf16 v[48:51], v[164:167], v[140:143], v[48:51]
  ds_read_b128 v[72:75], v6 offset:1088
  v_mfma_f32_16x16x32_bf16 v[52:55], v[164:167], v[144:147], v[52:55]
  ds_read_b128 v[76:79], v6 offset:1600
  v_mfma_f32_16x16x32_bf16 v[56:59], v[164:167], v[148:151], v[56:59]
  ds_read_b128 v[80:83], v6 offset:2112
  v_mfma_f32_16x16x32_bf16 v[60:63], v[164:167], v[152:155], v[60:63]
  ds_read_b128 v[84:87], v6 offset:2624
  s_waitcnt lgkmcnt(15)
  v_mfma_f32_16x16x32_bf16 v[40:43], v[168:171], v[128:131], v[40:43]
  ds_read_b128 v[88:91], v6 offset:3136
  v_mfma_f32_16x16x32_bf16 v[44:47], v[168:171], v[132:135], v[44:47]
  ds_read_b128 v[92:95], v6 offset:3648
  v_mfma_f32_16x16x32_bf16 v[48:51], v[168:171], v[136:139], v[48:51]
  ds_read_b128 v[100:103], v7 offset:640
  v_mfma_f32_16x16x32_bf16 v[52:55], v[168:171], v[140:143], v[52:55]
  ds_read_b128 v[104:107], v7 offset:1152
  v_mfma_f32_16x16x32_bf16 v[56:59], v[168:171], v[144:147], v[56:59]
  ds_read_b128 v[108:111], v7 offset:1664
  v_mfma_f32_16x16x32_bf16 v[60:63], v[168:171], v[148:151], v[60:63]
  ds_read_b128 v[112:115], v7 offset:2176
  v_mfma_f32_16x16x32_bf16 v[44:47], v[172:175], v[128:131], v[44:47]
  ds_read_b128 v[116:119], v7 offset:2688
  v_mfma_f32_16x16x32_bf16 v[48:51], v[172:175], v[132:135], v[48:51]
  ds_read_b128 v[120:123], v7 offset:3200
  v_mfma_f32_16x16x32_bf16 v[52:55], v[172:175], v[136:139], v[52:55]
  ds_read_b128 v[124:127], v7 offset:3712
  v_mfma_f32_16x16x32_bf16 v[56:59], v[172:175], v[140:143], v[56:59]
  s_add_u32 s14, s14, s15
  s_waitcnt lgkmcnt(15)
  v_mfma_f32_16x16x32_bf16 v[60:63], v[172:175], v[144:147], v[60:63]
  v_and_b32 v192, s81, v17
  v_lshlrev_b32 v193, 16, v17
  v_mfma_f32_16x16x32_bf16 v[48:51], v[176:179], v[128:131], v[48:51]
  v_and_b32 v194, s81, v16
  v_lshlrev_b32 v195, 16, v16
  v_mfma_f32_16x16x32_bf16 v[52:55], v[176:179], v[132:135], v[52:55]
  v_mul_f32 v192, s70, v192
  v_mul_f32 v193, s70, v193
  v_mfma_f32_16x16x32_bf16 v[56:59], v[176:179], v[136:139], v[56:59]
  v_mul_f32 v194, s70, v194
  v_mul_f32 v195, s70, v195
  v_mfma_f32_16x16x32_bf16 v[60:63], v[176:179], v[140:143], v[60:63]
  v_cvt_pk_bf16_f32 v16, v192, v193
  v_cvt_pk_bf16_f32 v17, v194, v195
  v_mfma_f32_16x16x32_bf16 v[52:55], v[180:183], v[128:131], v[52:55]
  v_lshlrev_b32 v192, 16, v16
  v_and_b32 v193, s81, v16
  v_mfma_f32_16x16x32_bf16 v[56:59], v[180:183], v[132:135], v[56:59]
  v_lshlrev_b32 v194, 16, v17
  v_and_b32 v195, s81, v17
  v_mfma_f32_16x16x32_bf16 v[60:63], v[180:183], v[136:139], v[60:63]
  v_and_b32 v196, s81, v19
  v_lshlrev_b32 v197, 16, v19
  v_mfma_f32_16x16x32_bf16 v[56:59], v[184:187], v[128:131], v[56:59]
  v_and_b32 v198, s81, v18
  v_lshlrev_b32 v199, 16, v18
  v_mfma_f32_16x16x32_bf16 v[60:63], v[184:187], v[132:135], v[60:63]
  v_mul_f32 v196, s70, v196
  v_mfma_f32_16x16x32_bf16 v[60:63], v[188:191], v[128:131], v[60:63]
  s_waitcnt lgkmcnt(7)
  v_mfma_f32_16x16x32_bf16 v[32:35], v[96:99], v[64:67], v[32:35]
  v_mul_f32 v197, s70, v197
  v_mul_f32 v198, s70, v198
  v_mfma_f32_16x16x32_bf16 v[36:39], v[96:99], v[68:71], v[36:39]
  v_mul_f32 v199, s70, v199
  v_cvt_pk_bf16_f32 v18, v196, v197
  v_mfma_f32_16x16x32_bf16 v[40:43], v[96:99], v[72:75], v[40:43]
  v_cvt_pk_bf16_f32 v19, v198, v199
  v_lshlrev_b32 v196, 16, v18
  v_mfma_f32_16x16x32_bf16 v[44:47], v[96:99], v[76:79], v[44:47]
  v_and_b32 v197, s81, v18
  v_lshlrev_b32 v198, 16, v19
  v_mfma_f32_16x16x32_bf16 v[48:51], v[96:99], v[80:83], v[48:51]
  v_and_b32 v199, s81, v19
  v_and_b32 v200, s81, v21
  v_mfma_f32_16x16x32_bf16 v[52:55], v[96:99], v[84:87], v[52:55]
  v_lshlrev_b32 v201, 16, v21
  v_and_b32 v202, s81, v20
  v_mfma_f32_16x16x32_bf16 v[56:59], v[96:99], v[88:91], v[56:59]
  v_lshlrev_b32 v203, 16, v20
  v_mul_f32 v200, s70, v200
  v_mfma_f32_16x16x32_bf16 v[60:63], v[96:99], v[92:95], v[60:63]
  v_mul_f32 v201, s70, v201
  v_mul_f32 v202, s70, v202
  s_waitcnt lgkmcnt(6)
  v_mfma_f32_16x16x32_bf16 v[36:39], v[100:103], v[64:67], v[36:39]
  ds_read_b128 v[128:131], v6 offset:0
  v_mul_f32 v203, s70, v203
  v_mfma_f32_16x16x32_bf16 v[40:43], v[100:103], v[68:71], v[40:43]
  ds_read_b128 v[160:163], v7 offset:192
  v_cvt_pk_bf16_f32 v20, v200, v201
  v_mfma_f32_16x16x32_bf16 v[44:47], v[100:103], v[72:75], v[44:47]
  ds_read_b128 v[132:135], v6 offset:512
  v_cvt_pk_bf16_f32 v21, v202, v203
  v_mfma_f32_16x16x32_bf16 v[48:51], v[100:103], v[76:79], v[48:51]
  ds_read_b128 v[136:139], v6 offset:1024
  v_lshlrev_b32 v200, 16, v20
  v_mfma_f32_16x16x32_bf16 v[52:55], v[100:103], v[80:83], v[52:55]
  ds_read_b128 v[140:143], v6 offset:1536
  v_and_b32 v201, s81, v20
  v_mfma_f32_16x16x32_bf16 v[56:59], v[100:103], v[84:87], v[56:59]
  ds_read_b128 v[144:147], v6 offset:2048
  v_lshlrev_b32 v202, 16, v21
  v_mfma_f32_16x16x32_bf16 v[60:63], v[100:103], v[88:91], v[60:63]
  ds_read_b128 v[148:151], v6 offset:2560
  v_and_b32 v203, s81, v21
  s_waitcnt lgkmcnt(12)
  v_mfma_f32_16x16x32_bf16 v[40:43], v[104:107], v[64:67], v[40:43]
  ds_read_b128 v[152:155], v6 offset:3072
  v_and_b32 v204, s81, v23
  v_mfma_f32_16x16x32_bf16 v[44:47], v[104:107], v[68:71], v[44:47]
  ds_read_b128 v[156:159], v6 offset:3584
  v_lshlrev_b32 v205, 16, v23
  v_mfma_f32_16x16x32_bf16 v[48:51], v[104:107], v[72:75], v[48:51]
  ds_read_b128 v[164:167], v7 offset:704
  v_and_b32 v206, s81, v22
  v_mfma_f32_16x16x32_bf16 v[52:55], v[104:107], v[76:79], v[52:55]
  ds_read_b128 v[168:171], v7 offset:1216
  v_lshlrev_b32 v207, 16, v22
  v_mfma_f32_16x16x32_bf16 v[56:59], v[104:107], v[80:83], v[56:59]
  ds_read_b128 v[172:175], v7 offset:1728
  v_mul_f32 v204, s70, v204
  v_mfma_f32_16x16x32_bf16 v[60:63], v[104:107], v[84:87], v[60:63]
  ds_read_b128 v[176:179], v7 offset:2240
  v_mul_f32 v205, s70, v205
  s_waitcnt lgkmcnt(15)
  v_mfma_f32_16x16x32_bf16 v[44:47], v[108:111], v[64:67], v[44:47]
  ds_read_b128 v[180:183], v7 offset:2752
  v_mul_f32 v206, s70, v206
  v_mfma_f32_16x16x32_bf16 v[48:51], v[108:111], v[68:71], v[48:51]
  ds_read_b128 v[184:187], v7 offset:3264
  v_mul_f32 v207, s70, v207
  v_mfma_f32_16x16x32_bf16 v[52:55], v[108:111], v[72:75], v[52:55]
  ds_read_b128 v[188:191], v7 offset:3776
  v_cvt_pk_bf16_f32 v22, v204, v205
  v_mfma_f32_16x16x32_bf16 v[56:59], v[108:111], v[76:79], v[56:59]
  v_cvt_pk_bf16_f32 v23, v206, v207
  v_lshlrev_b32 v204, 16, v22
  v_and_b32 v205, s81, v22
  v_mfma_f32_16x16x32_bf16 v[60:63], v[108:111], v[80:83], v[60:63]
  v_lshlrev_b32 v206, 16, v23
  v_and_b32 v207, s81, v23
  v_mfma_f32_16x16x32_bf16 v[48:51], v[112:115], v[64:67], v[48:51]
  v_mfma_f32_16x16x32_bf16 v[52:55], v[112:115], v[68:71], v[52:55]
  v_mfma_f32_16x16x32_bf16 v[56:59], v[112:115], v[72:75], v[56:59]
  v_mfma_f32_16x16x32_bf16 v[60:63], v[112:115], v[76:79], v[60:63]
  v_mfma_f32_16x16x32_bf16 v[52:55], v[116:119], v[64:67], v[52:55]
  v_mfma_f32_16x16x32_bf16 v[56:59], v[116:119], v[68:71], v[56:59]
  v_mfma_f32_16x16x32_bf16 v[60:63], v[116:119], v[72:75], v[60:63]
  s_waitcnt lgkmcnt(15)
  v_mfma_f32_16x16x32_bf16 v[56:59], v[120:123], v[64:67], v[56:59]
  v_mfma_f32_16x16x32_bf16 v[60:63], v[120:123], v[68:71], v[60:63]
  v_mfma_f32_16x16x32_bf16 v[60:63], v[124:127], v[64:67], v[60:63]
  s_waitcnt lgkmcnt(0)
  s_barrier
  s_cmp_eq_u32 s43, 1
  s_cbranch_scc1 Lr_22
  v_mfma_f32_16x16x32_bf16 v[48:51], v[160:163], v[144:147], v[48:51]
  v_mfma_f32_16x16x32_bf16 v[52:55], v[160:163], v[148:151], v[52:55]
  v_mfma_f32_16x16x32_bf16 v[56:59], v[160:163], v[152:155], v[56:59]
  v_mfma_f32_16x16x32_bf16 v[60:63], v[160:163], v[156:159], v[60:63]
  v_mfma_f32_16x16x32_bf16 v[48:51], v[164:167], v[140:143], v[48:51]
  v_mfma_f32_16x16x32_bf16 v[52:55], v[164:167], v[144:147], v[52:55]
  v_mfma_f32_16x16x32_bf16 v[56:59], v[164:167], v[148:151], v[56:59]
  v_mfma_f32_16x16x32_bf16 v[60:63], v[164:167], v[152:155], v[60:63]
  v_mfma_f32_16x16x32_bf16 v[48:51], v[168:171], v[136:139], v[48:51]
  v_mfma_f32_16x16x32_bf16 v[52:55], v[168:171], v[140:143], v[52:55]
  v_mfma_f32_16x16x32_bf16 v[56:59], v[168:171], v[144:147], v[56:59]
  v_mfma_f32_16x16x32_bf16 v[60:63], v[168:171], v[148:151], v[60:63]
  v_mfma_f32_16x16x32_bf16 v[48:51], v[172:175], v[132:135], v[48:51]
  v_mfma_f32_16x16x32_bf16 v[52:55], v[172:175], v[136:139], v[52:55]
  v_mfma_f32_16x16x32_bf16 v[56:59], v[172:175], v[140:143], v[56:59]
  v_mfma_f32_16x16x32_bf16 v[60:63], v[172:175], v[144:147], v[60:63]
  v_mfma_f32_16x16x32_bf16 v[48:51], v[176:179], v[128:131], v[48:51]
  v_mfma_f32_16x16x32_bf16 v[52:55], v[176:179], v[132:135], v[52:55]
  v_mfma_f32_16x16x32_bf16 v[56:59], v[176:179], v[136:139], v[56:59]
  v_mfma_f32_16x16x32_bf16 v[60:63], v[176:179], v[140:143], v[60:63]
  v_mfma_f32_16x16x32_bf16 v[52:55], v[180:183], v[128:131], v[52:55]
  v_mfma_f32_16x16x32_bf16 v[56:59], v[180:183], v[132:135], v[56:59]
  v_mfma_f32_16x16x32_bf16 v[60:63], v[180:183], v[136:139], v[60:63]
  v_mfma_f32_16x16x32_bf16 v[56:59], v[184:187], v[128:131], v[56:59]
  v_mfma_f32_16x16x32_bf16 v[60:63], v[184:187], v[132:135], v[60:63]
  v_mfma_f32_16x16x32_bf16 v[60:63], v[188:191], v[128:131], v[60:63]
  v_mfma_f32_16x16x32_bf16 v[32:35], v[160:163], v[128:131], v[32:35]
  v_mfma_f32_16x16x32_bf16 v[36:39], v[160:163], v[132:135], v[36:39]
  v_mfma_f32_16x16x32_bf16 v[40:43], v[160:163], v[136:139], v[40:43]
  v_mfma_f32_16x16x32_bf16 v[44:47], v[160:163], v[140:143], v[44:47]
  ds_write_b128 v28, v[48:51] offset:0
  v_mfma_f32_16x16x32_bf16 v[36:39], v[164:167], v[128:131], v[36:39]
  ds_write_b128 v28, v[52:55] offset:1024
  v_mfma_f32_16x16x32_bf16 v[40:43], v[164:167], v[132:135], v[40:43]
  ds_write_b128 v28, v[56:59] offset:2048
  v_mfma_f32_16x16x32_bf16 v[44:47], v[164:167], v[136:139], v[44:47]
  ds_write_b128 v28, v[60:63] offset:3072
  v_mfma_f32_16x16x32_bf16 v[40:43], v[168:171], v[128:131], v[40:43]
  v_mfma_f32_16x16x32_bf16 v[44:47], v[168:171], v[132:135], v[44:47]
  v_mfma_f32_16x16x32_bf16 v[44:47], v[172:175], v[128:131], v[44:47]
  s_waitcnt lgkmcnt(0)
  s_barrier
  ds_read_b128 v[64:67], v29 offset:0
  ds_read_b128 v[68:71], v29 offset:1024
  ds_read_b128 v[72:75], v29 offset:2048
  ds_read_b128 v[76:79], v29 offset:3072
  s_waitcnt lgkmcnt(3)
  v_pk_add_f32 v[32:33], v[32:33], v[64:65]
  v_pk_add_f32 v[34:35], v[34:35], v[66:67]
  v_cvt_pk_bf16_f32 v64, v32, v33
  v_cvt_pk_bf16_f32 v65, v34, v35
  v_lshlrev_b32 v32, 16, v64
  v_and_b32 v33, s81, v64
  v_lshlrev_b32 v34, 16, v65
  v_and_b32 v35, s81, v65
  v_pk_add_f32 v[32:33], v[32:33], v[192:193]
  v_pk_add_f32 v[34:35], v[34:35], v[194:195]
  v_cvt_pk_bf16_f32 v64, v32, v33
  v_cvt_pk_bf16_f32 v65, v34, v35
  buffer_store_dwordx2 v[64:65], v13, s[56:59], s14 offen sc1
  s_add_u32 s14, s14, 0x40000
  s_waitcnt lgkmcnt(2)
  v_pk_add_f32 v[36:37], v[36:37], v[68:69]
  v_pk_add_f32 v[38:39], v[38:39], v[70:71]
  v_cvt_pk_bf16_f32 v68, v36, v37
  v_cvt_pk_bf16_f32 v69, v38, v39
  v_lshlrev_b32 v36, 16, v68
  v_and_b32 v37, s81, v68
  v_lshlrev_b32 v38, 16, v69
  v_and_b32 v39, s81, v69
  v_pk_add_f32 v[36:37], v[36:37], v[196:197]
  v_pk_add_f32 v[38:39], v[38:39], v[198:199]
  v_cvt_pk_bf16_f32 v68, v36, v37
  v_cvt_pk_bf16_f32 v69, v38, v39
  buffer_store_dwordx2 v[68:69], v13, s[56:59], s14 offen sc1
  s_add_u32 s14, s14, 0x40000
  s_waitcnt lgkmcnt(1)
  v_pk_add_f32 v[40:41], v[40:41], v[72:73]
  v_pk_add_f32 v[42:43], v[42:43], v[74:75]
  v_cvt_pk_bf16_f32 v72, v40, v41
  v_cvt_pk_bf16_f32 v73, v42, v43
  v_lshlrev_b32 v40, 16, v72
  v_and_b32 v41, s81, v72
  v_lshlrev_b32 v42, 16, v73
  v_and_b32 v43, s81, v73
  v_pk_add_f32 v[40:41], v[40:41], v[200:201]
  v_pk_add_f32 v[42:43], v[42:43], v[202:203]
  v_cvt_pk_bf16_f32 v72, v40, v41
  v_cvt_pk_bf16_f32 v73, v42, v43
  buffer_store_dwordx2 v[72:73], v13, s[56:59], s14 offen sc1
  s_add_u32 s14, s14, 0x40000
  s_waitcnt lgkmcnt(0)
  v_pk_add_f32 v[44:45], v[44:45], v[76:77]
  v_pk_add_f32 v[46:47], v[46:47], v[78:79]
  v_cvt_pk_bf16_f32 v76, v44, v45
  v_cvt_pk_bf16_f32 v77, v46, v47
  v_lshlrev_b32 v44, 16, v76
  v_and_b32 v45, s81, v76
  v_lshlrev_b32 v46, 16, v77
  v_and_b32 v47, s81, v77
  v_pk_add_f32 v[44:45], v[44:45], v[204:205]
  v_pk_add_f32 v[46:47], v[46:47], v[206:207]
  v_cvt_pk_bf16_f32 v76, v44, v45
  v_cvt_pk_bf16_f32 v77, v46, v47
  buffer_store_dwordx2 v[76:77], v13, s[56:59], s14 offen sc1
  s_branch Lr_23
  s_nop 15
Lr_22:
  v_mfma_f32_16x16x32_bf16 v[32:35], v[160:163], v[128:131], v[32:35]
  v_mfma_f32_16x16x32_bf16 v[36:39], v[160:163], v[132:135], v[36:39]
  v_mfma_f32_16x16x32_bf16 v[40:43], v[160:163], v[136:139], v[40:43]
  v_mfma_f32_16x16x32_bf16 v[44:47], v[160:163], v[140:143], v[44:47]
  v_mfma_f32_16x16x32_bf16 v[36:39], v[164:167], v[128:131], v[36:39]
  v_mfma_f32_16x16x32_bf16 v[40:43], v[164:167], v[132:135], v[40:43]
  v_mfma_f32_16x16x32_bf16 v[44:47], v[164:167], v[136:139], v[44:47]
  v_mfma_f32_16x16x32_bf16 v[40:43], v[168:171], v[128:131], v[40:43]
  v_mfma_f32_16x16x32_bf16 v[44:47], v[168:171], v[132:135], v[44:47]
  v_mfma_f32_16x16x32_bf16 v[44:47], v[172:175], v[128:131], v[44:47]
  v_mfma_f32_16x16x32_bf16 v[48:51], v[160:163], v[144:147], v[48:51]
  v_mfma_f32_16x16x32_bf16 v[52:55], v[160:163], v[148:151], v[52:55]
  v_mfma_f32_16x16x32_bf16 v[56:59], v[160:163], v[152:155], v[56:59]
  v_mfma_f32_16x16x32_bf16 v[60:63], v[160:163], v[156:159], v[60:63]
  ds_write_b128 v28, v[32:35] offset:0
  v_mfma_f32_16x16x32_bf16 v[48:51], v[164:167], v[140:143], v[48:51]
  ds_write_b128 v28, v[36:39] offset:1024
  v_mfma_f32_16x16x32_bf16 v[52:55], v[164:167], v[144:147], v[52:55]
  ds_write_b128 v28, v[40:43] offset:2048
  v_mfma_f32_16x16x32_bf16 v[56:59], v[164:167], v[148:151], v[56:59]
  ds_write_b128 v28, v[44:47] offset:3072
  v_mfma_f32_16x16x32_bf16 v[60:63], v[164:167], v[152:155], v[60:63]
  v_mfma_f32_16x16x32_bf16 v[48:51], v[168:171], v[136:139], v[48:51]
  v_mfma_f32_16x16x32_bf16 v[52:55], v[168:171], v[140:143], v[52:55]
  v_mfma_f32_16x16x32_bf16 v[56:59], v[168:171], v[144:147], v[56:59]
  v_mfma_f32_16x16x32_bf16 v[60:63], v[168:171], v[148:151], v[60:63]
  v_mfma_f32_16x16x32_bf16 v[48:51], v[172:175], v[132:135], v[48:51]
  v_mfma_f32_16x16x32_bf16 v[52:55], v[172:175], v[136:139], v[52:55]
  v_mfma_f32_16x16x32_bf16 v[56:59], v[172:175], v[140:143], v[56:59]
  v_mfma_f32_16x16x32_bf16 v[60:63], v[172:175], v[144:147], v[60:63]
  v_mfma_f32_16x16x32_bf16 v[48:51], v[176:179], v[128:131], v[48:51]
  v_mfma_f32_16x16x32_bf16 v[52:55], v[176:179], v[132:135], v[52:55]
  v_mfma_f32_16x16x32_bf16 v[56:59], v[176:179], v[136:139], v[56:59]
  v_mfma_f32_16x16x32_bf16 v[60:63], v[176:179], v[140:143], v[60:63]
  v_mfma_f32_16x16x32_bf16 v[52:55], v[180:183], v[128:131], v[52:55]
  v_mfma_f32_16x16x32_bf16 v[56:59], v[180:183], v[132:135], v[56:59]
  v_mfma_f32_16x16x32_bf16 v[60:63], v[180:183], v[136:139], v[60:63]
  v_mfma_f32_16x16x32_bf16 v[56:59], v[184:187], v[128:131], v[56:59]
  v_mfma_f32_16x16x32_bf16 v[60:63], v[184:187], v[132:135], v[60:63]
  v_mfma_f32_16x16x32_bf16 v[60:63], v[188:191], v[128:131], v[60:63]
  s_waitcnt lgkmcnt(0)
  s_barrier
  ds_read_b128 v[64:67], v29 offset:0
  ds_read_b128 v[68:71], v29 offset:1024
  ds_read_b128 v[72:75], v29 offset:2048
  ds_read_b128 v[76:79], v29 offset:3072
  s_waitcnt lgkmcnt(3)
  v_pk_add_f32 v[48:49], v[48:49], v[64:65]
  v_pk_add_f32 v[50:51], v[50:51], v[66:67]
  v_cvt_pk_bf16_f32 v64, v48, v49
  v_cvt_pk_bf16_f32 v65, v50, v51
  v_lshlrev_b32 v48, 16, v64
  v_and_b32 v49, s81, v64
  v_lshlrev_b32 v50, 16, v65
  v_and_b32 v51, s81, v65
  v_pk_add_f32 v[48:49], v[48:49], v[192:193]
  v_pk_add_f32 v[50:51], v[50:51], v[194:195]
  v_cvt_pk_bf16_f32 v64, v48, v49
  v_cvt_pk_bf16_f32 v65, v50, v51
  buffer_store_dwordx2 v[64:65], v13, s[56:59], s14 offen sc1
  s_add_u32 s14, s14, 0x40000
  s_waitcnt lgkmcnt(2)
  v_pk_add_f32 v[52:53], v[52:53], v[68:69]
  v_pk_add_f32 v[54:55], v[54:55], v[70:71]
  v_cvt_pk_bf16_f32 v68, v52, v53
  v_cvt_pk_bf16_f32 v69, v54, v55
  v_lshlrev_b32 v52, 16, v68
  v_and_b32 v53, s81, v68
  v_lshlrev_b32 v54, 16, v69
  v_and_b32 v55, s81, v69
  v_pk_add_f32 v[52:53], v[52:53], v[196:197]
  v_pk_add_f32 v[54:55], v[54:55], v[198:199]
  v_cvt_pk_bf16_f32 v68, v52, v53
  v_cvt_pk_bf16_f32 v69, v54, v55
  buffer_store_dwordx2 v[68:69], v13, s[56:59], s14 offen sc1
  s_add_u32 s14, s14, 0x40000
  s_waitcnt lgkmcnt(1)
  v_pk_add_f32 v[56:57], v[56:57], v[72:73]
  v_pk_add_f32 v[58:59], v[58:59], v[74:75]
  v_cvt_pk_bf16_f32 v72, v56, v57
  v_cvt_pk_bf16_f32 v73, v58, v59
  v_lshlrev_b32 v56, 16, v72
  v_and_b32 v57, s81, v72
  v_lshlrev_b32 v58, 16, v73
  v_and_b32 v59, s81, v73
  v_pk_add_f32 v[56:57], v[56:57], v[200:201]
  v_pk_add_f32 v[58:59], v[58:59], v[202:203]
  v_cvt_pk_bf16_f32 v72, v56, v57
  v_cvt_pk_bf16_f32 v73, v58, v59
  buffer_store_dwordx2 v[72:73], v13, s[56:59], s14 offen sc1
  s_add_u32 s14, s14, 0x40000
  s_waitcnt lgkmcnt(0)
  v_pk_add_f32 v[60:61], v[60:61], v[76:77]
  v_pk_add_f32 v[62:63], v[62:63], v[78:79]
  v_cvt_pk_bf16_f32 v76, v60, v61
  v_cvt_pk_bf16_f32 v77, v62, v63
  v_lshlrev_b32 v60, 16, v76
  v_and_b32 v61, s81, v76
  v_lshlrev_b32 v62, 16, v77
  v_and_b32 v63, s81, v77
  v_pk_add_f32 v[60:61], v[60:61], v[204:205]
  v_pk_add_f32 v[62:63], v[62:63], v[206:207]
  v_cvt_pk_bf16_f32 v76, v60, v61
  v_cvt_pk_bf16_f32 v77, v62, v63
  buffer_store_dwordx2 v[76:77], v13, s[56:59], s14 offen sc1
Lr_23:
  s_waitcnt vmcnt(0)
  s_barrier
  s_lshl_b32 s14, s5, 7
  s_add_u32 s14, s14, 32768
  s_cmp_lg_u32 s7, 0
  s_cbranch_scc1 Lsf_24
  v_mov_b32 v8, s82
  s_mov_b64 exec, 1
  buffer_store_dword v8, off, s[76:79], s14 sc1
  s_mov_b64 exec, -1
Lsf_24:
  s_endpgm
Lend:
  s_endpgm
.section .rodata,"a"
.p2align 6
.amdhsa_kernel parallel_sum__ssm_conv_s4d__dense_activation_relu__prompt_kernel
.amdhsa_next_free_vgpr 256
.amdhsa_next_free_sgpr 102
.amdhsa_accum_offset 256
.amdhsa_group_segment_fixed_size 0
.amdhsa_float_denorm_mode_32 3
.amdhsa_kernarg_size 104
.amdhsa_user_sgpr_count 2
.amdhsa_user_sgpr_kernarg_segment_ptr 1
.amdhsa_system_sgpr_workgroup_id_x 1
.end_amdhsa_kernel
```
